```python
import torch

def _softmax(x, axis=-1):
    return torch.softmax(x, dim=axis)
def _gelu(x):
    return torch.nn.functional.gelu(x, approximate="tanh")
def _silu(x):
    return torch.nn.functional.silu(x)
def _sigmoid(x):
    return torch.sigmoid(x)
def _layernorm(x, axis=-1, eps=1e-5):
    m = x.mean(dim=axis, keepdim=True)
    v = x.var(dim=axis, keepdim=True, unbiased=False)
    return (x - m) / torch.sqrt(v + eps)
def _scatter_add(tgt, idx, src, axis=0):
    return tgt.clone().index_add_(axis, idx, src)
def _segment_sum(src, seg, n):
    out = torch.zeros((n,) + src.shape[1:], dtype=src.dtype)
    return out.index_add_(0, seg, src)
def _pad(x, pw):
    flat = tuple(v for pair in reversed(pw) for v in pair)
    return torch.nn.functional.pad(x, flat)

kernel_name = 'standalone__mha_block_cached__near_ridge'

def setup_inputs():

    _w = (lambda a: (lambda t: t.to(torch.bfloat16) if t.is_floating_point() else t)(torch.as_tensor(a)))
    B, Sq, D = 16, 112, 576
    H, Sk, Dh = 32, 1024, 128
    return {
        "x": _w((lambda *s: torch.randn(*s, dtype=torch.bfloat16) * 0.8)(B, Sq, D)),
        "k_cache": _w((lambda *s: torch.randn(*s, dtype=torch.bfloat16) * 0.8)(B, H, Sk, Dh)),
        "v_cache": _w((lambda *s: torch.randn(*s, dtype=torch.bfloat16) * 0.05)(B, H, Sk, Dh)),
        "wq": _w((lambda *s: torch.randn(*s, dtype=torch.bfloat16) * 0.8)(D, H * Dh) * (D ** -0.5)),
        "wo": _w((lambda *s: torch.randn(*s, dtype=torch.bfloat16) * 0.05)(H * Dh, D) * ((H * Dh) ** -0.5)),
    }

def reference(x, k_cache, v_cache, wq, wo):
    B, Sq, D = x.shape
    H, Dh = 32, 128
    q = (lambda x, *d: x.permute(*d))((x @ wq).reshape(B, Sq, H, Dh), 0, 2, 1, 3)
    scores = torch.einsum("bhqd,bhkd->bhqk", q, k_cache) * (Dh ** -0.5)
    p = _softmax(scores, axis=-1)
    o = torch.einsum("bhqk,bhkd->bhqd", p, v_cache)
    return (lambda x, *d: x.permute(*d))(o, 0, 2, 1, 3).reshape(B, Sq, H * Dh) @ wo
```

```asm
; @launch grid=(512,1,1) block=(256,1,1) lds=81920
.amdgcn_target "amdgcn-amd-amdhsa--gfx950"
.text
.globl standalone__mha_block_cached__near_ridge_kernel
.p2align 8
.type standalone__mha_block_cached__near_ridge_kernel,@function
standalone__mha_block_cached__near_ridge_kernel:
    s_cmp_ge_u32 s2, 512
    s_cbranch_scc1 K1_END
    s_load_dwordx4 s[24:27], s[0:1], 0
    s_load_dwordx4 s[28:31], s[0:1], 16
    s_load_dwordx2 s[32:33], s[0:1], 56
    s_load_dwordx2 s[52:53], s[0:1], 48
    s_load_dwordx2 s[54:55], s[0:1], 56
    s_and_b32 s3, s2, 3
    s_lshl_b32 s3, s3, 2
    s_bfe_u32 s48, s2, 0x20003
    s_add_u32 s51, s48, s3
    s_lshr_b32 s3, s2, 8
    s_lshl_b32 s3, s3, 4
    s_add_u32 s34, s51, s3
    s_bfe_u32 s3, s2, 0x10002
    s_lshl_b32 s3, s3, 3
    s_bfe_u32 s35, s2, 0x30005
    s_add_u32 s35, s35, s3
    v_lshrrev_b32 v240, 6, v0
    v_and_b32 v244, 63, v0
    s_lshl_b32 s37, s35, 5
    v_readfirstlane_b32 s36, v240
    s_add_u32 s37, s37, s34
    s_lshl_b32 s37, s37, 18
    s_lshl_b32 s38, s34, 8
    s_mul_i32 s39, s35, 129024
    s_lshl_b32 s40, s36, 12
    s_waitcnt lgkmcnt(0)
    s_add_u32 s12, s30, s38
    s_addc_u32 s13, s31, 0
    s_mov_b32 s14, 4718592
    s_mov_b32 s15, 0x00020000
    s_sub_u32 s14, s14, s38
    s_add_u32 s16, s24, s39
    s_addc_u32 s17, s25, 0
    s_mov_b32 s18, 129024
    s_mov_b32 s19, 0x00020000
    s_add_u32 s4, s26, s37
    s_addc_u32 s5, s27, 0
    s_mov_b32 s6, 262144
    s_mov_b32 s7, 0x00020000
    s_add_u32 s8, s28, s37
    s_addc_u32 s9, s29, 0
    s_mov_b32 s10, 262144
    s_mov_b32 s11, 0x00020000
    s_mov_b32 s20, s32
    s_mov_b32 s21, s33
    s_mov_b32 s22, 14680064
    s_mov_b32 s23, 0x00020000
    v_lshrrev_b32 v240, 4, v0
    v_and_b32 v241, 3, v240
    v_lshrrev_b32 v240, 6, v0
    v_lshl_add_u32 v240, v240, 4, v241
    v_and_b32 v232, 15, v0
    v_lshlrev_b32 v234, 2, v241
    v_xor_b32 v234, v234, v232
    v_lshlrev_b32 v234, 4, v234
    v_lshl_add_u32 v229, v240, 13, v234
    v_lshl_add_u32 v228, v240, 8, v234
    v_xor_b32 v234, v241, v232
    v_lshlrev_b32 v234, 4, v234
    v_lshl_add_u32 v224, v240, 8, v234
    v_xor_b32 v225, 64, v224
    v_xor_b32 v226, 0x80, v224
    v_xor_b32 v227, 0xc0, v224
    v_and_b32 v240, 31, v0
    s_lshl_b32 s41, s36, 5
    v_add_u32 v240, s41, v240
    v_lshrrev_b32 v241, 5, v244
    v_lshrrev_b32 v232, 3, v244
    v_add_u32 v232, s41, v232
    v_add_u32 v232, 0, v232
    v_min_u32 v232, 111, v232
    v_mul_u32_u24 v232, 1152, v232
    v_lshrrev_b32 v234, 4, v244
    v_xor_b32 v234, v234, v244
    v_xor_b32 v234, 0, v234
    v_and_b32 v234, 7, v234
    v_lshl_add_u32 v232, v234, 4, v232
    v_subrev_u32 v136, 0, v232
    v_lshrrev_b32 v232, 3, v244
    v_add_u32 v232, s41, v232
    v_add_u32 v232, 8, v232
    v_min_u32 v232, 111, v232
    v_mul_u32_u24 v232, 1152, v232
    v_lshrrev_b32 v234, 4, v244
    v_xor_b32 v234, v234, v244
    v_xor_b32 v234, 4, v234
    v_and_b32 v234, 7, v234
    v_lshl_add_u32 v232, v234, 4, v232
    v_subrev_u32 v137, 1024, v232
    v_lshrrev_b32 v232, 3, v244
    v_add_u32 v232, s41, v232
    v_add_u32 v232, 16, v232
    v_min_u32 v232, 111, v232
    v_mul_u32_u24 v232, 1152, v232
    v_lshrrev_b32 v234, 4, v244
    v_xor_b32 v234, v234, v244
    v_xor_b32 v234, 0, v234
    v_and_b32 v234, 7, v234
    v_lshl_add_u32 v232, v234, 4, v232
    v_subrev_u32 v138, 2048, v232
    v_lshrrev_b32 v232, 3, v244
    v_add_u32 v232, s41, v232
    v_add_u32 v232, 24, v232
    v_min_u32 v232, 111, v232
    v_mul_u32_u24 v232, 1152, v232
    v_lshrrev_b32 v234, 4, v244
    v_xor_b32 v234, v234, v244
    v_xor_b32 v234, 4, v234
    v_and_b32 v234, 7, v234
    v_lshl_add_u32 v232, v234, 4, v232
    v_subrev_u32 v139, 3072, v232
    s_lshl_b32 s48, s48, 1
    s_and_b32 s49, s35, 7
    s_add_u32 s48, s48, s49
    s_mul_i32 s48, s48, 1
    s_sub_u32 s49, s48, 9
    s_cselect_b32 s48, s48, s49
    s_add_u32 s56, s54, 16777216
    s_addc_u32 s57, s55, 0
    s_lshr_b32 s3, s2, 8
    s_lshl_b32 s3, s3, 4
    s_add_u32 s3, s3, s35
    s_lshl_b32 s3, s3, 5
    s_add_u32 s3, s3, s51
    s_lshl_b32 s3, s3, 2
    v_mov_b32 v246, s3
    s_and_b32 s3, s2, 255
    s_add_u32 s3, s3, 32
    s_lshl_b32 s3, s3, 7
    v_mov_b32 v223, s3
    v_mov_b32 v247, 1
    v_mov_b32 v231, 0
    s_cmp_lg_u32 s2, 0
    s_cbranch_scc1 K1_NZ
    v_lshlrev_b32 v236, 4, v0
    v_mov_b32 v4, 0
    v_mov_b32 v5, 0
    v_mov_b32 v6, 0
    v_mov_b32 v7, 0
    global_store_dwordx4 v236, v[4:7], s[56:57] sc1
    v_lshlrev_b32 v237, 7, v0
    v_add_u32 v237, 4096, v237

    s_waitcnt vmcnt(0)
    s_barrier
    s_mov_b64 exec, 1
    global_store_dword v4, v247, s[52:53] sc1
    global_store_dword v4, v247, s[52:53] offset:128 sc1
    s_mov_b64 exec, -1
K1_NZ:
    s_setprio 3
    s_cmp_lt_u32 s2, 256
    s_cbranch_scc1 K1_GO
    s_setprio 0
K1_GOB:
K1_GO:
    s_lshl_b32 s49, s48, 7
    s_lshl_b32 s50, s48, 19
    s_add_u32 s48, s48, 1
    s_cmp_eq_u32 s48, 9
    s_cselect_b32 s48, 0, s48
    s_add_u32 m0, s40, 32768
    s_nop 0
    buffer_load_dwordx4 v136, s[16:19], s49 offen offset:0 lds
    buffer_load_dwordx4 v137, s[16:19], s49 offen offset:1024 lds
    buffer_load_dwordx4 v138, s[16:19], s49 offen offset:2048 lds
    buffer_load_dwordx4 v139, s[16:19], s49 offen offset:3072 lds
    s_add_u32 m0, s40, 65536
    s_add_u32 s42, s50, 0
    buffer_load_dwordx4 v229, s[12:15], s42 offen lds
    s_add_u32 m0, s40, 66560
    s_add_u32 s42, s50, 32768
    buffer_load_dwordx4 v229, s[12:15], s42 offen lds
    s_add_u32 m0, s40, 67584
    s_add_u32 s42, s50, 65536
    buffer_load_dwordx4 v229, s[12:15], s42 offen lds
    s_add_u32 m0, s40, 68608
    s_add_u32 s42, s50, 98304
    buffer_load_dwordx4 v229, s[12:15], s42 offen lds
    s_lshl_b32 s49, s48, 7
    s_lshl_b32 s50, s48, 19
    s_add_u32 s48, s48, 1
    s_cmp_eq_u32 s48, 9
    s_cselect_b32 s48, 0, s48
    s_add_u32 m0, s40, 0
    s_nop 0
    buffer_load_dwordx4 v136, s[16:19], s49 offen offset:0 lds
    buffer_load_dwordx4 v137, s[16:19], s49 offen offset:1024 lds
    buffer_load_dwordx4 v138, s[16:19], s49 offen offset:2048 lds
    buffer_load_dwordx4 v139, s[16:19], s49 offen offset:3072 lds
    s_add_u32 m0, s40, 16384
    s_add_u32 s42, s50, 0
    buffer_load_dwordx4 v229, s[12:15], s42 offen lds
    s_add_u32 m0, s40, 17408
    s_add_u32 s42, s50, 32768
    buffer_load_dwordx4 v229, s[12:15], s42 offen lds
    s_add_u32 m0, s40, 18432
    s_add_u32 s42, s50, 65536
    buffer_load_dwordx4 v229, s[12:15], s42 offen lds
    s_add_u32 m0, s40, 19456
    s_add_u32 s42, s50, 98304
    buffer_load_dwordx4 v229, s[12:15], s42 offen lds
    s_mul_i32 s41, s35, 112
    v_cmp_gt_u32 vcc, 112, v240
    v_add_u32 v240, s41, v240
    v_lshrrev_b32 v245, 5, v240
    v_lshlrev_b32 v245, 18, v245
    v_and_b32 v240, 31, v240
    v_lshl_add_u32 v245, v240, 4, v245
    v_lshl_add_u32 v245, v241, 9, v245
    s_lshl_b32 s41, s34, 13
    v_add_u32 v245, s41, v245
    v_mov_b32 v240, 0x7fff0000
    v_cndmask_b32 v245, v240, v245, vcc
    v_and_b32 v240, 31, v0
    v_lshlrev_b32 v220, 8, v240
    v_and_b32 v240, 15, v0
    v_xor_b32 v240, v240, v241
    v_lshl_add_u32 v220, v240, 4, v220
    v_bfe_u32 v240, v0, 2, 2
    v_mul_u32_u24 v221, 320, v240
    v_bfe_u32 v240, v0, 4, 1
    v_lshl_add_u32 v221, v240, 5, v221
    v_and_b32 v240, 1, v0
    v_lshl_add_u32 v221, v240, 4, v221
    v_bfe_u32 v240, v0, 1, 1
    v_lshl_add_u32 v221, v240, 3, v221
    v_lshl_add_u32 v222, v241, 11, v221
    v_lshl_add_u32 v221, v241, 10, v221
    v_mov_b32 v242, 0x3e0293ee
    v_and_b32 v240, 31, v0
    v_lshlrev_b32 v140, 7, v240
    v_add_u32 v140, s40, v140
    v_bfe_u32 v240, v0, 1, 3
    v_xor_b32 v240, v240, v241
    v_lshl_add_u32 v140, v240, 4, v140
    v_xor_b32 v141, 32, v140
    v_xor_b32 v142, 64, v140
    v_xor_b32 v143, 96, v140
    s_waitcnt vmcnt(8)
    s_barrier
    ds_read_b128 v[64:67], v140 offset:32768
    ds_read_b128 v[68:71], v141 offset:32768
    ds_read_b128 v[72:75], v142 offset:32768
    ds_read_b128 v[76:79], v143 offset:32768
    v_add_u32 v216, 65536, v222
    v_xor_b32 v217, 0x40, v216
    v_xor_b32 v218, 0x80, v216
    v_xor_b32 v219, 0xc0, v216
    ds_read_b64_tr_b16 v[144:145], v216 offset:0
    ds_read_b64_tr_b16 v[146:147], v216 offset:1024
    ds_read_b64_tr_b16 v[148:149], v217 offset:0
    ds_read_b64_tr_b16 v[150:151], v217 offset:1024
    ds_read_b64_tr_b16 v[152:153], v218 offset:0
    ds_read_b64_tr_b16 v[154:155], v218 offset:1024
    ds_read_b64_tr_b16 v[156:157], v219 offset:0
    ds_read_b64_tr_b16 v[158:159], v219 offset:1024
    s_lshl_b32 s49, s48, 7
    s_lshl_b32 s50, s48, 19
    s_add_u32 s48, s48, 1
    s_cmp_eq_u32 s48, 9
    s_cselect_b32 s48, 0, s48
    ds_read_b64_tr_b16 v[160:161], v216 offset:4096
    ds_read_b64_tr_b16 v[162:163], v216 offset:5120
    s_waitcnt lgkmcnt(8)
    v_mfma_f32_32x32x16_bf16 v[0:15], v[144:147], v[64:67], 0
    s_add_u32 m0, s40, 49152
    s_add_u32 s42, s50, 0
    buffer_load_dwordx4 v229, s[12:15], s42 offen lds
    ds_read_b64_tr_b16 v[164:165], v217 offset:4096
    ds_read_b64_tr_b16 v[166:167], v217 offset:5120
    s_waitcnt lgkmcnt(8)
    v_mfma_f32_32x32x16_bf16 v[16:31], v[148:151], v[64:67], 0
    s_add_u32 m0, s40, 50176
    s_add_u32 s42, s50, 32768
    buffer_load_dwordx4 v229, s[12:15], s42 offen lds
    ds_read_b64_tr_b16 v[168:169], v218 offset:4096
    ds_read_b64_tr_b16 v[170:171], v218 offset:5120
    s_waitcnt lgkmcnt(8)
    v_mfma_f32_32x32x16_bf16 v[32:47], v[152:155], v[64:67], 0
    s_add_u32 m0, s40, 51200
    s_add_u32 s42, s50, 65536
    buffer_load_dwordx4 v229, s[12:15], s42 offen lds
    ds_read_b64_tr_b16 v[172:173], v219 offset:4096
    ds_read_b64_tr_b16 v[174:175], v219 offset:5120
    s_waitcnt lgkmcnt(8)
    v_mfma_f32_32x32x16_bf16 v[48:63], v[156:159], v[64:67], 0
    s_add_u32 m0, s40, 52224
    s_add_u32 s42, s50, 98304
    buffer_load_dwordx4 v229, s[12:15], s42 offen lds
    ds_read_b64_tr_b16 v[176:177], v216 offset:8192
    ds_read_b64_tr_b16 v[178:179], v216 offset:9216
    s_waitcnt lgkmcnt(8)
    v_mfma_f32_32x32x16_bf16 v[0:15], v[160:163], v[68:71], v[0:15]
    s_add_u32 m0, s40, 32768
    s_nop 0
    ds_read_b64_tr_b16 v[180:181], v217 offset:8192
    ds_read_b64_tr_b16 v[182:183], v217 offset:9216
    s_waitcnt lgkmcnt(8)
    v_mfma_f32_32x32x16_bf16 v[16:31], v[164:167], v[68:71], v[16:31]
    buffer_load_dwordx4 v136, s[16:19], s49 offen offset:0 lds
    ds_read_b64_tr_b16 v[184:185], v218 offset:8192
    ds_read_b64_tr_b16 v[186:187], v218 offset:9216
    s_waitcnt lgkmcnt(8)
    v_mfma_f32_32x32x16_bf16 v[32:47], v[168:171], v[68:71], v[32:47]
    buffer_load_dwordx4 v137, s[16:19], s49 offen offset:1024 lds
    ds_read_b64_tr_b16 v[188:189], v219 offset:8192
    ds_read_b64_tr_b16 v[190:191], v219 offset:9216
    s_waitcnt lgkmcnt(8)
    v_mfma_f32_32x32x16_bf16 v[48:63], v[172:175], v[68:71], v[48:63]
    buffer_load_dwordx4 v138, s[16:19], s49 offen offset:2048 lds
    ds_read_b64_tr_b16 v[192:193], v216 offset:12288
    ds_read_b64_tr_b16 v[194:195], v216 offset:13312
    s_waitcnt lgkmcnt(8)
    v_mfma_f32_32x32x16_bf16 v[0:15], v[176:179], v[72:75], v[0:15]
    buffer_load_dwordx4 v139, s[16:19], s49 offen offset:3072 lds
    ds_read_b64_tr_b16 v[196:197], v217 offset:12288
    ds_read_b64_tr_b16 v[198:199], v217 offset:13312
    s_waitcnt lgkmcnt(8)
    v_mfma_f32_32x32x16_bf16 v[16:31], v[180:183], v[72:75], v[16:31]
    ds_read_b64_tr_b16 v[200:201], v218 offset:12288
    ds_read_b64_tr_b16 v[202:203], v218 offset:13312
    s_waitcnt lgkmcnt(8)
    v_mfma_f32_32x32x16_bf16 v[32:47], v[184:187], v[72:75], v[32:47]
    ds_read_b64_tr_b16 v[204:205], v219 offset:12288
    ds_read_b64_tr_b16 v[206:207], v219 offset:13312
    s_waitcnt lgkmcnt(8)
    v_mfma_f32_32x32x16_bf16 v[48:63], v[188:191], v[72:75], v[48:63]
    s_waitcnt lgkmcnt(6)
    v_mfma_f32_32x32x16_bf16 v[0:15], v[192:195], v[76:79], v[0:15]
    s_waitcnt lgkmcnt(4)
    v_mfma_f32_32x32x16_bf16 v[16:31], v[196:199], v[76:79], v[16:31]
    s_waitcnt lgkmcnt(2)
    v_mfma_f32_32x32x16_bf16 v[32:47], v[200:203], v[76:79], v[32:47]
    s_waitcnt lgkmcnt(0)
    v_mfma_f32_32x32x16_bf16 v[48:63], v[204:207], v[76:79], v[48:63]
    s_waitcnt vmcnt(8)
    s_barrier
    ds_read_b128 v[80:83], v140 offset:0
    ds_read_b128 v[84:87], v141 offset:0
    ds_read_b128 v[88:91], v142 offset:0
    ds_read_b128 v[92:95], v143 offset:0
    v_add_u32 v216, 16384, v222
    v_xor_b32 v217, 0x40, v216
    v_xor_b32 v218, 0x80, v216
    v_xor_b32 v219, 0xc0, v216
    ds_read_b64_tr_b16 v[144:145], v216 offset:0
    ds_read_b64_tr_b16 v[146:147], v216 offset:1024
    ds_read_b64_tr_b16 v[148:149], v217 offset:0
    ds_read_b64_tr_b16 v[150:151], v217 offset:1024
    ds_read_b64_tr_b16 v[152:153], v218 offset:0
    ds_read_b64_tr_b16 v[154:155], v218 offset:1024
    ds_read_b64_tr_b16 v[156:157], v219 offset:0
    ds_read_b64_tr_b16 v[158:159], v219 offset:1024
    s_lshl_b32 s49, s48, 7
    s_lshl_b32 s50, s48, 19
    s_add_u32 s48, s48, 1
    s_cmp_eq_u32 s48, 9
    s_cselect_b32 s48, 0, s48
    ds_read_b64_tr_b16 v[160:161], v216 offset:4096
    ds_read_b64_tr_b16 v[162:163], v216 offset:5120
    s_waitcnt lgkmcnt(8)
    v_mfma_f32_32x32x16_bf16 v[0:15], v[144:147], v[80:83], v[0:15]
    s_add_u32 m0, s40, 65536
    s_add_u32 s42, s50, 0
    buffer_load_dwordx4 v229, s[12:15], s42 offen lds
    ds_read_b64_tr_b16 v[164:165], v217 offset:4096
    ds_read_b64_tr_b16 v[166:167], v217 offset:5120
    s_waitcnt lgkmcnt(8)
    v_mfma_f32_32x32x16_bf16 v[16:31], v[148:151], v[80:83], v[16:31]
    s_add_u32 m0, s40, 66560
    s_add_u32 s42, s50, 32768
    buffer_load_dwordx4 v229, s[12:15], s42 offen lds
    ds_read_b64_tr_b16 v[168:169], v218 offset:4096
    ds_read_b64_tr_b16 v[170:171], v218 offset:5120
    s_waitcnt lgkmcnt(8)
    v_mfma_f32_32x32x16_bf16 v[32:47], v[152:155], v[80:83], v[32:47]
    s_add_u32 m0, s40, 67584
    s_add_u32 s42, s50, 65536
    buffer_load_dwordx4 v229, s[12:15], s42 offen lds
    ds_read_b64_tr_b16 v[172:173], v219 offset:4096
    ds_read_b64_tr_b16 v[174:175], v219 offset:5120
    s_waitcnt lgkmcnt(8)
    v_mfma_f32_32x32x16_bf16 v[48:63], v[156:159], v[80:83], v[48:63]
    s_add_u32 m0, s40, 68608
    s_add_u32 s42, s50, 98304
    buffer_load_dwordx4 v229, s[12:15], s42 offen lds
    ds_read_b64_tr_b16 v[176:177], v216 offset:8192
    ds_read_b64_tr_b16 v[178:179], v216 offset:9216
    s_waitcnt lgkmcnt(8)
    v_mfma_f32_32x32x16_bf16 v[0:15], v[160:163], v[84:87], v[0:15]
    s_add_u32 m0, s40, 0
    s_nop 0
    ds_read_b64_tr_b16 v[180:181], v217 offset:8192
    ds_read_b64_tr_b16 v[182:183], v217 offset:9216
    s_waitcnt lgkmcnt(8)
    v_mfma_f32_32x32x16_bf16 v[16:31], v[164:167], v[84:87], v[16:31]
    buffer_load_dwordx4 v136, s[16:19], s49 offen offset:0 lds
    ds_read_b64_tr_b16 v[184:185], v218 offset:8192
    ds_read_b64_tr_b16 v[186:187], v218 offset:9216
    s_waitcnt lgkmcnt(8)
    v_mfma_f32_32x32x16_bf16 v[32:47], v[168:171], v[84:87], v[32:47]
    buffer_load_dwordx4 v137, s[16:19], s49 offen offset:1024 lds
    ds_read_b64_tr_b16 v[188:189], v219 offset:8192
    ds_read_b64_tr_b16 v[190:191], v219 offset:9216
    s_waitcnt lgkmcnt(8)
    v_mfma_f32_32x32x16_bf16 v[48:63], v[172:175], v[84:87], v[48:63]
    buffer_load_dwordx4 v138, s[16:19], s49 offen offset:2048 lds
    ds_read_b64_tr_b16 v[192:193], v216 offset:12288
    ds_read_b64_tr_b16 v[194:195], v216 offset:13312
    s_waitcnt lgkmcnt(8)
    v_mfma_f32_32x32x16_bf16 v[0:15], v[176:179], v[88:91], v[0:15]
    buffer_load_dwordx4 v139, s[16:19], s49 offen offset:3072 lds
    ds_read_b64_tr_b16 v[196:197], v217 offset:12288
    ds_read_b64_tr_b16 v[198:199], v217 offset:13312
    s_waitcnt lgkmcnt(8)
    v_mfma_f32_32x32x16_bf16 v[16:31], v[180:183], v[88:91], v[16:31]
    ds_read_b64_tr_b16 v[200:201], v218 offset:12288
    ds_read_b64_tr_b16 v[202:203], v218 offset:13312
    s_waitcnt lgkmcnt(8)
    v_mfma_f32_32x32x16_bf16 v[32:47], v[184:187], v[88:91], v[32:47]
    ds_read_b64_tr_b16 v[204:205], v219 offset:12288
    ds_read_b64_tr_b16 v[206:207], v219 offset:13312
    s_waitcnt lgkmcnt(8)
    v_mfma_f32_32x32x16_bf16 v[48:63], v[188:191], v[88:91], v[48:63]
    s_waitcnt lgkmcnt(6)
    v_mfma_f32_32x32x16_bf16 v[0:15], v[192:195], v[92:95], v[0:15]
    s_waitcnt lgkmcnt(4)
    v_mfma_f32_32x32x16_bf16 v[16:31], v[196:199], v[92:95], v[16:31]
    s_waitcnt lgkmcnt(2)
    v_mfma_f32_32x32x16_bf16 v[32:47], v[200:203], v[92:95], v[32:47]
    s_waitcnt lgkmcnt(0)
    v_mfma_f32_32x32x16_bf16 v[48:63], v[204:207], v[92:95], v[48:63]
    s_waitcnt vmcnt(8)
    s_barrier
    ds_read_b128 v[64:67], v140 offset:32768
    ds_read_b128 v[68:71], v141 offset:32768
    ds_read_b128 v[72:75], v142 offset:32768
    ds_read_b128 v[76:79], v143 offset:32768
    v_add_u32 v216, 49152, v222
    v_xor_b32 v217, 0x40, v216
    v_xor_b32 v218, 0x80, v216
    v_xor_b32 v219, 0xc0, v216
    ds_read_b64_tr_b16 v[144:145], v216 offset:0
    ds_read_b64_tr_b16 v[146:147], v216 offset:1024
    ds_read_b64_tr_b16 v[148:149], v217 offset:0
    ds_read_b64_tr_b16 v[150:151], v217 offset:1024
    ds_read_b64_tr_b16 v[152:153], v218 offset:0
    ds_read_b64_tr_b16 v[154:155], v218 offset:1024
    ds_read_b64_tr_b16 v[156:157], v219 offset:0
    ds_read_b64_tr_b16 v[158:159], v219 offset:1024
    s_lshl_b32 s49, s48, 7
    s_lshl_b32 s50, s48, 19
    s_add_u32 s48, s48, 1
    s_cmp_eq_u32 s48, 9
    s_cselect_b32 s48, 0, s48
    ds_read_b64_tr_b16 v[160:161], v216 offset:4096
    ds_read_b64_tr_b16 v[162:163], v216 offset:5120
    s_waitcnt lgkmcnt(8)
    v_mfma_f32_32x32x16_bf16 v[0:15], v[144:147], v[64:67], v[0:15]
    s_add_u32 m0, s40, 16384
    s_add_u32 s42, s50, 0
    buffer_load_dwordx4 v229, s[12:15], s42 offen lds
    ds_read_b64_tr_b16 v[164:165], v217 offset:4096
    ds_read_b64_tr_b16 v[166:167], v217 offset:5120
    s_waitcnt lgkmcnt(8)
    v_mfma_f32_32x32x16_bf16 v[16:31], v[148:151], v[64:67], v[16:31]
    s_add_u32 m0, s40, 17408
    s_add_u32 s42, s50, 32768
    buffer_load_dwordx4 v229, s[12:15], s42 offen lds
    ds_read_b64_tr_b16 v[168:169], v218 offset:4096
    ds_read_b64_tr_b16 v[170:171], v218 offset:5120
    s_waitcnt lgkmcnt(8)
    v_mfma_f32_32x32x16_bf16 v[32:47], v[152:155], v[64:67], v[32:47]
    s_add_u32 m0, s40, 18432
    s_add_u32 s42, s50, 65536
    buffer_load_dwordx4 v229, s[12:15], s42 offen lds
    ds_read_b64_tr_b16 v[172:173], v219 offset:4096
    ds_read_b64_tr_b16 v[174:175], v219 offset:5120
    s_waitcnt lgkmcnt(8)
    v_mfma_f32_32x32x16_bf16 v[48:63], v[156:159], v[64:67], v[48:63]
    s_add_u32 m0, s40, 19456
    s_add_u32 s42, s50, 98304
    buffer_load_dwordx4 v229, s[12:15], s42 offen lds
    ds_read_b64_tr_b16 v[176:177], v216 offset:8192
    ds_read_b64_tr_b16 v[178:179], v216 offset:9216
    s_waitcnt lgkmcnt(8)
    v_mfma_f32_32x32x16_bf16 v[0:15], v[160:163], v[68:71], v[0:15]
    s_add_u32 m0, s40, 32768
    s_nop 0
    ds_read_b64_tr_b16 v[180:181], v217 offset:8192
    ds_read_b64_tr_b16 v[182:183], v217 offset:9216
    s_waitcnt lgkmcnt(8)
    v_mfma_f32_32x32x16_bf16 v[16:31], v[164:167], v[68:71], v[16:31]
    buffer_load_dwordx4 v136, s[16:19], s49 offen offset:0 lds
    ds_read_b64_tr_b16 v[184:185], v218 offset:8192
    ds_read_b64_tr_b16 v[186:187], v218 offset:9216
    s_waitcnt lgkmcnt(8)
    v_mfma_f32_32x32x16_bf16 v[32:47], v[168:171], v[68:71], v[32:47]
    buffer_load_dwordx4 v137, s[16:19], s49 offen offset:1024 lds
    ds_read_b64_tr_b16 v[188:189], v219 offset:8192
    ds_read_b64_tr_b16 v[190:191], v219 offset:9216
    s_waitcnt lgkmcnt(8)
    v_mfma_f32_32x32x16_bf16 v[48:63], v[172:175], v[68:71], v[48:63]
    buffer_load_dwordx4 v138, s[16:19], s49 offen offset:2048 lds
    ds_read_b64_tr_b16 v[192:193], v216 offset:12288
    ds_read_b64_tr_b16 v[194:195], v216 offset:13312
    s_waitcnt lgkmcnt(8)
    v_mfma_f32_32x32x16_bf16 v[0:15], v[176:179], v[72:75], v[0:15]
    buffer_load_dwordx4 v139, s[16:19], s49 offen offset:3072 lds
    ds_read_b64_tr_b16 v[196:197], v217 offset:12288
    ds_read_b64_tr_b16 v[198:199], v217 offset:13312
    s_waitcnt lgkmcnt(8)
    v_mfma_f32_32x32x16_bf16 v[16:31], v[180:183], v[72:75], v[16:31]
    ds_read_b64_tr_b16 v[200:201], v218 offset:12288
    ds_read_b64_tr_b16 v[202:203], v218 offset:13312
    s_waitcnt lgkmcnt(8)
    v_mfma_f32_32x32x16_bf16 v[32:47], v[184:187], v[72:75], v[32:47]
    ds_read_b64_tr_b16 v[204:205], v219 offset:12288
    ds_read_b64_tr_b16 v[206:207], v219 offset:13312
    s_waitcnt lgkmcnt(8)
    v_mfma_f32_32x32x16_bf16 v[48:63], v[188:191], v[72:75], v[48:63]
    s_waitcnt lgkmcnt(6)
    v_mfma_f32_32x32x16_bf16 v[0:15], v[192:195], v[76:79], v[0:15]
    s_waitcnt lgkmcnt(4)
    v_mfma_f32_32x32x16_bf16 v[16:31], v[196:199], v[76:79], v[16:31]
    s_waitcnt lgkmcnt(2)
    v_mfma_f32_32x32x16_bf16 v[32:47], v[200:203], v[76:79], v[32:47]
    s_waitcnt lgkmcnt(0)
    v_mfma_f32_32x32x16_bf16 v[48:63], v[204:207], v[76:79], v[48:63]
    s_waitcnt vmcnt(8)
    s_barrier
    ds_read_b128 v[80:83], v140 offset:0
    ds_read_b128 v[84:87], v141 offset:0
    ds_read_b128 v[88:91], v142 offset:0
    ds_read_b128 v[92:95], v143 offset:0
    v_add_u32 v216, 65536, v222
    v_xor_b32 v217, 0x40, v216
    v_xor_b32 v218, 0x80, v216
    v_xor_b32 v219, 0xc0, v216
    ds_read_b64_tr_b16 v[144:145], v216 offset:0
    ds_read_b64_tr_b16 v[146:147], v216 offset:1024
    ds_read_b64_tr_b16 v[148:149], v217 offset:0
    ds_read_b64_tr_b16 v[150:151], v217 offset:1024
    ds_read_b64_tr_b16 v[152:153], v218 offset:0
    ds_read_b64_tr_b16 v[154:155], v218 offset:1024
    ds_read_b64_tr_b16 v[156:157], v219 offset:0
    ds_read_b64_tr_b16 v[158:159], v219 offset:1024
    s_lshl_b32 s49, s48, 7
    s_lshl_b32 s50, s48, 19
    s_add_u32 s48, s48, 1
    s_cmp_eq_u32 s48, 9
    s_cselect_b32 s48, 0, s48
    ds_read_b64_tr_b16 v[160:161], v216 offset:4096
    ds_read_b64_tr_b16 v[162:163], v216 offset:5120
    s_waitcnt lgkmcnt(8)
    v_mfma_f32_32x32x16_bf16 v[0:15], v[144:147], v[80:83], v[0:15]
    s_add_u32 m0, s40, 49152
    s_add_u32 s42, s50, 0
    buffer_load_dwordx4 v229, s[12:15], s42 offen lds
    ds_read_b64_tr_b16 v[164:165], v217 offset:4096
    ds_read_b64_tr_b16 v[166:167], v217 offset:5120
    s_waitcnt lgkmcnt(8)
    v_mfma_f32_32x32x16_bf16 v[16:31], v[148:151], v[80:83], v[16:31]
    s_add_u32 m0, s40, 50176
    s_add_u32 s42, s50, 32768
    buffer_load_dwordx4 v229, s[12:15], s42 offen lds
    ds_read_b64_tr_b16 v[168:169], v218 offset:4096
    ds_read_b64_tr_b16 v[170:171], v218 offset:5120
    s_waitcnt lgkmcnt(8)
    v_mfma_f32_32x32x16_bf16 v[32:47], v[152:155], v[80:83], v[32:47]
    s_add_u32 m0, s40, 51200
    s_add_u32 s42, s50, 65536
    buffer_load_dwordx4 v229, s[12:15], s42 offen lds
    ds_read_b64_tr_b16 v[172:173], v219 offset:4096
    ds_read_b64_tr_b16 v[174:175], v219 offset:5120
    s_waitcnt lgkmcnt(8)
    v_mfma_f32_32x32x16_bf16 v[48:63], v[156:159], v[80:83], v[48:63]
    s_add_u32 m0, s40, 52224
    s_add_u32 s42, s50, 98304
    buffer_load_dwordx4 v229, s[12:15], s42 offen lds
    ds_read_b64_tr_b16 v[176:177], v216 offset:8192
    ds_read_b64_tr_b16 v[178:179], v216 offset:9216
    s_waitcnt lgkmcnt(8)
    v_mfma_f32_32x32x16_bf16 v[0:15], v[160:163], v[84:87], v[0:15]
    s_add_u32 m0, s40, 0
    s_nop 0
    ds_read_b64_tr_b16 v[180:181], v217 offset:8192
    ds_read_b64_tr_b16 v[182:183], v217 offset:9216
    s_waitcnt lgkmcnt(8)
    v_mfma_f32_32x32x16_bf16 v[16:31], v[164:167], v[84:87], v[16:31]
    buffer_load_dwordx4 v136, s[16:19], s49 offen offset:0 lds
    ds_read_b64_tr_b16 v[184:185], v218 offset:8192
    ds_read_b64_tr_b16 v[186:187], v218 offset:9216
    s_waitcnt lgkmcnt(8)
    v_mfma_f32_32x32x16_bf16 v[32:47], v[168:171], v[84:87], v[32:47]
    buffer_load_dwordx4 v137, s[16:19], s49 offen offset:1024 lds
    ds_read_b64_tr_b16 v[188:189], v219 offset:8192
    ds_read_b64_tr_b16 v[190:191], v219 offset:9216
    s_waitcnt lgkmcnt(8)
    v_mfma_f32_32x32x16_bf16 v[48:63], v[172:175], v[84:87], v[48:63]
    buffer_load_dwordx4 v138, s[16:19], s49 offen offset:2048 lds
    ds_read_b64_tr_b16 v[192:193], v216 offset:12288
    ds_read_b64_tr_b16 v[194:195], v216 offset:13312
    s_waitcnt lgkmcnt(8)
    v_mfma_f32_32x32x16_bf16 v[0:15], v[176:179], v[88:91], v[0:15]
    buffer_load_dwordx4 v139, s[16:19], s49 offen offset:3072 lds
    ds_read_b64_tr_b16 v[196:197], v217 offset:12288
    ds_read_b64_tr_b16 v[198:199], v217 offset:13312
    s_waitcnt lgkmcnt(8)
    v_mfma_f32_32x32x16_bf16 v[16:31], v[180:183], v[88:91], v[16:31]
    ds_read_b64_tr_b16 v[200:201], v218 offset:12288
    ds_read_b64_tr_b16 v[202:203], v218 offset:13312
    s_waitcnt lgkmcnt(8)
    v_mfma_f32_32x32x16_bf16 v[32:47], v[184:187], v[88:91], v[32:47]
    ds_read_b64_tr_b16 v[204:205], v219 offset:12288
    ds_read_b64_tr_b16 v[206:207], v219 offset:13312
    s_waitcnt lgkmcnt(8)
    v_mfma_f32_32x32x16_bf16 v[48:63], v[188:191], v[88:91], v[48:63]
    s_waitcnt lgkmcnt(6)
    v_mfma_f32_32x32x16_bf16 v[0:15], v[192:195], v[92:95], v[0:15]
    s_waitcnt lgkmcnt(4)
    v_mfma_f32_32x32x16_bf16 v[16:31], v[196:199], v[92:95], v[16:31]
    s_waitcnt lgkmcnt(2)
    v_mfma_f32_32x32x16_bf16 v[32:47], v[200:203], v[92:95], v[32:47]
    s_waitcnt lgkmcnt(0)
    v_mfma_f32_32x32x16_bf16 v[48:63], v[204:207], v[92:95], v[48:63]
    s_waitcnt vmcnt(8)
    s_barrier
    ds_read_b128 v[64:67], v140 offset:32768
    ds_read_b128 v[68:71], v141 offset:32768
    ds_read_b128 v[72:75], v142 offset:32768
    ds_read_b128 v[76:79], v143 offset:32768
    v_add_u32 v216, 16384, v222
    v_xor_b32 v217, 0x40, v216
    v_xor_b32 v218, 0x80, v216
    v_xor_b32 v219, 0xc0, v216
    ds_read_b64_tr_b16 v[144:145], v216 offset:0
    ds_read_b64_tr_b16 v[146:147], v216 offset:1024
    ds_read_b64_tr_b16 v[148:149], v217 offset:0
    ds_read_b64_tr_b16 v[150:151], v217 offset:1024
    ds_read_b64_tr_b16 v[152:153], v218 offset:0
    ds_read_b64_tr_b16 v[154:155], v218 offset:1024
    ds_read_b64_tr_b16 v[156:157], v219 offset:0
    ds_read_b64_tr_b16 v[158:159], v219 offset:1024
    s_lshl_b32 s49, s48, 7
    s_lshl_b32 s50, s48, 19
    s_add_u32 s48, s48, 1
    s_cmp_eq_u32 s48, 9
    s_cselect_b32 s48, 0, s48
    ds_read_b64_tr_b16 v[160:161], v216 offset:4096
    ds_read_b64_tr_b16 v[162:163], v216 offset:5120
    s_waitcnt lgkmcnt(8)
    v_mfma_f32_32x32x16_bf16 v[0:15], v[144:147], v[64:67], v[0:15]
    s_add_u32 m0, s40, 65536
    s_add_u32 s42, s50, 0
    buffer_load_dwordx4 v229, s[12:15], s42 offen lds
    ds_read_b64_tr_b16 v[164:165], v217 offset:4096
    ds_read_b64_tr_b16 v[166:167], v217 offset:5120
    s_waitcnt lgkmcnt(8)
    v_mfma_f32_32x32x16_bf16 v[16:31], v[148:151], v[64:67], v[16:31]
    s_add_u32 m0, s40, 66560
    s_add_u32 s42, s50, 32768
    buffer_load_dwordx4 v229, s[12:15], s42 offen lds
    ds_read_b64_tr_b16 v[168:169], v218 offset:4096
    ds_read_b64_tr_b16 v[170:171], v218 offset:5120
    s_waitcnt lgkmcnt(8)
    v_mfma_f32_32x32x16_bf16 v[32:47], v[152:155], v[64:67], v[32:47]
    s_add_u32 m0, s40, 67584
    s_add_u32 s42, s50, 65536
    buffer_load_dwordx4 v229, s[12:15], s42 offen lds
    ds_read_b64_tr_b16 v[172:173], v219 offset:4096
    ds_read_b64_tr_b16 v[174:175], v219 offset:5120
    s_waitcnt lgkmcnt(8)
    v_mfma_f32_32x32x16_bf16 v[48:63], v[156:159], v[64:67], v[48:63]
    s_add_u32 m0, s40, 68608
    s_add_u32 s42, s50, 98304
    buffer_load_dwordx4 v229, s[12:15], s42 offen lds
    ds_read_b64_tr_b16 v[176:177], v216 offset:8192
    ds_read_b64_tr_b16 v[178:179], v216 offset:9216
    s_waitcnt lgkmcnt(8)
    v_mfma_f32_32x32x16_bf16 v[0:15], v[160:163], v[68:71], v[0:15]
    s_add_u32 m0, s40, 32768
    s_nop 0
    ds_read_b64_tr_b16 v[180:181], v217 offset:8192
    ds_read_b64_tr_b16 v[182:183], v217 offset:9216
    s_waitcnt lgkmcnt(8)
    v_mfma_f32_32x32x16_bf16 v[16:31], v[164:167], v[68:71], v[16:31]
    buffer_load_dwordx4 v136, s[16:19], s49 offen offset:0 lds
    ds_read_b64_tr_b16 v[184:185], v218 offset:8192
    ds_read_b64_tr_b16 v[186:187], v218 offset:9216
    s_waitcnt lgkmcnt(8)
    v_mfma_f32_32x32x16_bf16 v[32:47], v[168:171], v[68:71], v[32:47]
    buffer_load_dwordx4 v137, s[16:19], s49 offen offset:1024 lds
    ds_read_b64_tr_b16 v[188:189], v219 offset:8192
    ds_read_b64_tr_b16 v[190:191], v219 offset:9216
    s_waitcnt lgkmcnt(8)
    v_mfma_f32_32x32x16_bf16 v[48:63], v[172:175], v[68:71], v[48:63]
    buffer_load_dwordx4 v138, s[16:19], s49 offen offset:2048 lds
    ds_read_b64_tr_b16 v[192:193], v216 offset:12288
    ds_read_b64_tr_b16 v[194:195], v216 offset:13312
    s_waitcnt lgkmcnt(8)
    v_mfma_f32_32x32x16_bf16 v[0:15], v[176:179], v[72:75], v[0:15]
    buffer_load_dwordx4 v139, s[16:19], s49 offen offset:3072 lds
    ds_read_b64_tr_b16 v[196:197], v217 offset:12288
    ds_read_b64_tr_b16 v[198:199], v217 offset:13312
    s_waitcnt lgkmcnt(8)
    v_mfma_f32_32x32x16_bf16 v[16:31], v[180:183], v[72:75], v[16:31]
    ds_read_b64_tr_b16 v[200:201], v218 offset:12288
    ds_read_b64_tr_b16 v[202:203], v218 offset:13312
    s_waitcnt lgkmcnt(8)
    v_mfma_f32_32x32x16_bf16 v[32:47], v[184:187], v[72:75], v[32:47]
    ds_read_b64_tr_b16 v[204:205], v219 offset:12288
    ds_read_b64_tr_b16 v[206:207], v219 offset:13312
    s_waitcnt lgkmcnt(8)
    v_mfma_f32_32x32x16_bf16 v[48:63], v[188:191], v[72:75], v[48:63]
    s_waitcnt lgkmcnt(6)
    v_mfma_f32_32x32x16_bf16 v[0:15], v[192:195], v[76:79], v[0:15]
    s_waitcnt lgkmcnt(4)
    v_mfma_f32_32x32x16_bf16 v[16:31], v[196:199], v[76:79], v[16:31]
    s_waitcnt lgkmcnt(2)
    v_mfma_f32_32x32x16_bf16 v[32:47], v[200:203], v[76:79], v[32:47]
    s_waitcnt lgkmcnt(0)
    v_mfma_f32_32x32x16_bf16 v[48:63], v[204:207], v[76:79], v[48:63]
    s_waitcnt vmcnt(8)
    s_barrier
    ds_read_b128 v[80:83], v140 offset:0
    ds_read_b128 v[84:87], v141 offset:0
    ds_read_b128 v[88:91], v142 offset:0
    ds_read_b128 v[92:95], v143 offset:0
    v_add_u32 v216, 49152, v222
    v_xor_b32 v217, 0x40, v216
    v_xor_b32 v218, 0x80, v216
    v_xor_b32 v219, 0xc0, v216
    ds_read_b64_tr_b16 v[144:145], v216 offset:0
    ds_read_b64_tr_b16 v[146:147], v216 offset:1024
    ds_read_b64_tr_b16 v[148:149], v217 offset:0
    ds_read_b64_tr_b16 v[150:151], v217 offset:1024
    ds_read_b64_tr_b16 v[152:153], v218 offset:0
    ds_read_b64_tr_b16 v[154:155], v218 offset:1024
    ds_read_b64_tr_b16 v[156:157], v219 offset:0
    ds_read_b64_tr_b16 v[158:159], v219 offset:1024
    s_lshl_b32 s49, s48, 7
    s_lshl_b32 s50, s48, 19
    s_add_u32 s48, s48, 1
    s_cmp_eq_u32 s48, 9
    s_cselect_b32 s48, 0, s48
    ds_read_b64_tr_b16 v[160:161], v216 offset:4096
    ds_read_b64_tr_b16 v[162:163], v216 offset:5120
    s_waitcnt lgkmcnt(8)
    v_mfma_f32_32x32x16_bf16 v[0:15], v[144:147], v[80:83], v[0:15]
    s_add_u32 m0, s40, 16384
    s_add_u32 s42, s50, 0
    buffer_load_dwordx4 v229, s[12:15], s42 offen lds
    ds_read_b64_tr_b16 v[164:165], v217 offset:4096
    ds_read_b64_tr_b16 v[166:167], v217 offset:5120
    s_waitcnt lgkmcnt(8)
    v_mfma_f32_32x32x16_bf16 v[16:31], v[148:151], v[80:83], v[16:31]
    s_add_u32 m0, s40, 17408
    s_add_u32 s42, s50, 32768
    buffer_load_dwordx4 v229, s[12:15], s42 offen lds
    ds_read_b64_tr_b16 v[168:169], v218 offset:4096
    ds_read_b64_tr_b16 v[170:171], v218 offset:5120
    s_waitcnt lgkmcnt(8)
    v_mfma_f32_32x32x16_bf16 v[32:47], v[152:155], v[80:83], v[32:47]
    s_add_u32 m0, s40, 18432
    s_add_u32 s42, s50, 65536
    buffer_load_dwordx4 v229, s[12:15], s42 offen lds
    ds_read_b64_tr_b16 v[172:173], v219 offset:4096
    ds_read_b64_tr_b16 v[174:175], v219 offset:5120
    s_waitcnt lgkmcnt(8)
    v_mfma_f32_32x32x16_bf16 v[48:63], v[156:159], v[80:83], v[48:63]
    s_add_u32 m0, s40, 19456
    s_add_u32 s42, s50, 98304
    buffer_load_dwordx4 v229, s[12:15], s42 offen lds
    ds_read_b64_tr_b16 v[176:177], v216 offset:8192
    ds_read_b64_tr_b16 v[178:179], v216 offset:9216
    s_waitcnt lgkmcnt(8)
    v_mfma_f32_32x32x16_bf16 v[0:15], v[160:163], v[84:87], v[0:15]
    s_add_u32 m0, s40, 0
    s_nop 0
    ds_read_b64_tr_b16 v[180:181], v217 offset:8192
    ds_read_b64_tr_b16 v[182:183], v217 offset:9216
    s_waitcnt lgkmcnt(8)
    v_mfma_f32_32x32x16_bf16 v[16:31], v[164:167], v[84:87], v[16:31]
    buffer_load_dwordx4 v136, s[16:19], s49 offen offset:0 lds
    ds_read_b64_tr_b16 v[184:185], v218 offset:8192
    ds_read_b64_tr_b16 v[186:187], v218 offset:9216
    s_waitcnt lgkmcnt(8)
    v_mfma_f32_32x32x16_bf16 v[32:47], v[168:171], v[84:87], v[32:47]
    buffer_load_dwordx4 v137, s[16:19], s49 offen offset:1024 lds
    ds_read_b64_tr_b16 v[188:189], v219 offset:8192
    ds_read_b64_tr_b16 v[190:191], v219 offset:9216
    s_waitcnt lgkmcnt(8)
    v_mfma_f32_32x32x16_bf16 v[48:63], v[172:175], v[84:87], v[48:63]
    buffer_load_dwordx4 v138, s[16:19], s49 offen offset:2048 lds
    ds_read_b64_tr_b16 v[192:193], v216 offset:12288
    ds_read_b64_tr_b16 v[194:195], v216 offset:13312
    s_waitcnt lgkmcnt(8)
    v_mfma_f32_32x32x16_bf16 v[0:15], v[176:179], v[88:91], v[0:15]
    buffer_load_dwordx4 v139, s[16:19], s49 offen offset:3072 lds
    ds_read_b64_tr_b16 v[196:197], v217 offset:12288
    ds_read_b64_tr_b16 v[198:199], v217 offset:13312
    s_waitcnt lgkmcnt(8)
    v_mfma_f32_32x32x16_bf16 v[16:31], v[180:183], v[88:91], v[16:31]
    ds_read_b64_tr_b16 v[200:201], v218 offset:12288
    ds_read_b64_tr_b16 v[202:203], v218 offset:13312
    s_waitcnt lgkmcnt(8)
    v_mfma_f32_32x32x16_bf16 v[32:47], v[184:187], v[88:91], v[32:47]
    ds_read_b64_tr_b16 v[204:205], v219 offset:12288
    ds_read_b64_tr_b16 v[206:207], v219 offset:13312
    s_waitcnt lgkmcnt(8)
    v_mfma_f32_32x32x16_bf16 v[48:63], v[188:191], v[88:91], v[48:63]
    s_waitcnt lgkmcnt(6)
    v_mfma_f32_32x32x16_bf16 v[0:15], v[192:195], v[92:95], v[0:15]
    s_waitcnt lgkmcnt(4)
    v_mfma_f32_32x32x16_bf16 v[16:31], v[196:199], v[92:95], v[16:31]
    s_waitcnt lgkmcnt(2)
    v_mfma_f32_32x32x16_bf16 v[32:47], v[200:203], v[92:95], v[32:47]
    s_waitcnt lgkmcnt(0)
    v_mfma_f32_32x32x16_bf16 v[48:63], v[204:207], v[92:95], v[48:63]
    s_waitcnt vmcnt(8)
    s_barrier
    ds_read_b128 v[64:67], v140 offset:32768
    ds_read_b128 v[68:71], v141 offset:32768
    ds_read_b128 v[72:75], v142 offset:32768
    ds_read_b128 v[76:79], v143 offset:32768
    v_add_u32 v216, 65536, v222
    v_xor_b32 v217, 0x40, v216
    v_xor_b32 v218, 0x80, v216
    v_xor_b32 v219, 0xc0, v216
    ds_read_b64_tr_b16 v[144:145], v216 offset:0
    ds_read_b64_tr_b16 v[146:147], v216 offset:1024
    ds_read_b64_tr_b16 v[148:149], v217 offset:0
    ds_read_b64_tr_b16 v[150:151], v217 offset:1024
    ds_read_b64_tr_b16 v[152:153], v218 offset:0
    ds_read_b64_tr_b16 v[154:155], v218 offset:1024
    ds_read_b64_tr_b16 v[156:157], v219 offset:0
    ds_read_b64_tr_b16 v[158:159], v219 offset:1024
    s_lshl_b32 s49, s48, 7
    s_lshl_b32 s50, s48, 19
    s_add_u32 s48, s48, 1
    s_cmp_eq_u32 s48, 9
    s_cselect_b32 s48, 0, s48
    ds_read_b64_tr_b16 v[160:161], v216 offset:4096
    ds_read_b64_tr_b16 v[162:163], v216 offset:5120
    s_waitcnt lgkmcnt(8)
    v_mfma_f32_32x32x16_bf16 v[0:15], v[144:147], v[64:67], v[0:15]
    s_add_u32 m0, s40, 49152
    s_add_u32 s42, s50, 0
    buffer_load_dwordx4 v229, s[12:15], s42 offen lds
    ds_read_b64_tr_b16 v[164:165], v217 offset:4096
    ds_read_b64_tr_b16 v[166:167], v217 offset:5120
    s_waitcnt lgkmcnt(8)
    v_mfma_f32_32x32x16_bf16 v[16:31], v[148:151], v[64:67], v[16:31]
    s_add_u32 m0, s40, 50176
    s_add_u32 s42, s50, 32768
    buffer_load_dwordx4 v229, s[12:15], s42 offen lds
    ds_read_b64_tr_b16 v[168:169], v218 offset:4096
    ds_read_b64_tr_b16 v[170:171], v218 offset:5120
    s_waitcnt lgkmcnt(8)
    v_mfma_f32_32x32x16_bf16 v[32:47], v[152:155], v[64:67], v[32:47]
    s_add_u32 m0, s40, 51200
    s_add_u32 s42, s50, 65536
    buffer_load_dwordx4 v229, s[12:15], s42 offen lds
    ds_read_b64_tr_b16 v[172:173], v219 offset:4096
    ds_read_b64_tr_b16 v[174:175], v219 offset:5120
    s_waitcnt lgkmcnt(8)
    v_mfma_f32_32x32x16_bf16 v[48:63], v[156:159], v[64:67], v[48:63]
    s_add_u32 m0, s40, 52224
    s_add_u32 s42, s50, 98304
    buffer_load_dwordx4 v229, s[12:15], s42 offen lds
    ds_read_b64_tr_b16 v[176:177], v216 offset:8192
    ds_read_b64_tr_b16 v[178:179], v216 offset:9216
    s_waitcnt lgkmcnt(8)
    v_mfma_f32_32x32x16_bf16 v[0:15], v[160:163], v[68:71], v[0:15]
    s_add_u32 m0, s40, 32768
    s_nop 0
    ds_read_b64_tr_b16 v[180:181], v217 offset:8192
    ds_read_b64_tr_b16 v[182:183], v217 offset:9216
    s_waitcnt lgkmcnt(8)
    v_mfma_f32_32x32x16_bf16 v[16:31], v[164:167], v[68:71], v[16:31]
    buffer_load_dwordx4 v136, s[16:19], s49 offen offset:0 lds
    ds_read_b64_tr_b16 v[184:185], v218 offset:8192
    ds_read_b64_tr_b16 v[186:187], v218 offset:9216
    s_waitcnt lgkmcnt(8)
    v_mfma_f32_32x32x16_bf16 v[32:47], v[168:171], v[68:71], v[32:47]
    buffer_load_dwordx4 v137, s[16:19], s49 offen offset:1024 lds
    ds_read_b64_tr_b16 v[188:189], v219 offset:8192
    ds_read_b64_tr_b16 v[190:191], v219 offset:9216
    s_waitcnt lgkmcnt(8)
    v_mfma_f32_32x32x16_bf16 v[48:63], v[172:175], v[68:71], v[48:63]
    buffer_load_dwordx4 v138, s[16:19], s49 offen offset:2048 lds
    ds_read_b64_tr_b16 v[192:193], v216 offset:12288
    ds_read_b64_tr_b16 v[194:195], v216 offset:13312
    s_waitcnt lgkmcnt(8)
    v_mfma_f32_32x32x16_bf16 v[0:15], v[176:179], v[72:75], v[0:15]
    buffer_load_dwordx4 v139, s[16:19], s49 offen offset:3072 lds
    ds_read_b64_tr_b16 v[196:197], v217 offset:12288
    ds_read_b64_tr_b16 v[198:199], v217 offset:13312
    s_waitcnt lgkmcnt(8)
    v_mfma_f32_32x32x16_bf16 v[16:31], v[180:183], v[72:75], v[16:31]
    ds_read_b64_tr_b16 v[200:201], v218 offset:12288
    ds_read_b64_tr_b16 v[202:203], v218 offset:13312
    s_waitcnt lgkmcnt(8)
    v_mfma_f32_32x32x16_bf16 v[32:47], v[184:187], v[72:75], v[32:47]
    ds_read_b64_tr_b16 v[204:205], v219 offset:12288
    ds_read_b64_tr_b16 v[206:207], v219 offset:13312
    s_waitcnt lgkmcnt(8)
    v_mfma_f32_32x32x16_bf16 v[48:63], v[188:191], v[72:75], v[48:63]
    s_waitcnt lgkmcnt(6)
    v_mfma_f32_32x32x16_bf16 v[0:15], v[192:195], v[76:79], v[0:15]
    s_waitcnt lgkmcnt(4)
    v_mfma_f32_32x32x16_bf16 v[16:31], v[196:199], v[76:79], v[16:31]
    s_waitcnt lgkmcnt(2)
    v_mfma_f32_32x32x16_bf16 v[32:47], v[200:203], v[76:79], v[32:47]
    s_waitcnt lgkmcnt(0)
    v_mfma_f32_32x32x16_bf16 v[48:63], v[204:207], v[76:79], v[48:63]
    v_mov_b32 v236, 1
    s_cmp_lg_u32 s36, 0
    s_cbranch_scc1 K1_NR
    global_load_dword v236, v231, s[52:53] offset:128
K1_NR:
    s_waitcnt vmcnt(8)
    s_barrier
    ds_read_b128 v[80:83], v140 offset:0
    ds_read_b128 v[84:87], v141 offset:0
    ds_read_b128 v[88:91], v142 offset:0
    ds_read_b128 v[92:95], v143 offset:0
    v_add_u32 v216, 16384, v222
    v_xor_b32 v217, 0x40, v216
    v_xor_b32 v218, 0x80, v216
    v_xor_b32 v219, 0xc0, v216
    ds_read_b64_tr_b16 v[144:145], v216 offset:0
    ds_read_b64_tr_b16 v[146:147], v216 offset:1024
    ds_read_b64_tr_b16 v[148:149], v217 offset:0
    ds_read_b64_tr_b16 v[150:151], v217 offset:1024
    ds_read_b64_tr_b16 v[152:153], v218 offset:0
    ds_read_b64_tr_b16 v[154:155], v218 offset:1024
    ds_read_b64_tr_b16 v[156:157], v219 offset:0
    ds_read_b64_tr_b16 v[158:159], v219 offset:1024
    s_mov_b32 s42, 16384
    ds_read_b64_tr_b16 v[160:161], v216 offset:4096
    ds_read_b64_tr_b16 v[162:163], v216 offset:5120
    s_waitcnt lgkmcnt(8)
    v_mfma_f32_32x32x16_bf16 v[0:15], v[144:147], v[80:83], v[0:15]
    s_add_u32 m0, s40, 65536
    s_nop 0
    ds_read_b64_tr_b16 v[164:165], v217 offset:4096
    ds_read_b64_tr_b16 v[166:167], v217 offset:5120
    s_waitcnt lgkmcnt(8)
    v_mfma_f32_32x32x16_bf16 v[16:31], v[148:151], v[80:83], v[16:31]
    buffer_load_dwordx4 v224, s[4:7], 0 offen offset:0 nt lds
    ds_read_b64_tr_b16 v[168:169], v218 offset:4096
    ds_read_b64_tr_b16 v[170:171], v218 offset:5120
    s_waitcnt lgkmcnt(8)
    v_mfma_f32_32x32x16_bf16 v[32:47], v[152:155], v[80:83], v[32:47]
    buffer_load_dwordx4 v225, s[4:7], 0 offen offset:1024 nt lds
    ds_read_b64_tr_b16 v[172:173], v219 offset:4096
    ds_read_b64_tr_b16 v[174:175], v219 offset:5120
    s_waitcnt lgkmcnt(8)
    v_mfma_f32_32x32x16_bf16 v[48:63], v[156:159], v[80:83], v[48:63]
    buffer_load_dwordx4 v226, s[4:7], 0 offen offset:2048 nt lds
    ds_read_b64_tr_b16 v[176:177], v216 offset:8192
    ds_read_b64_tr_b16 v[178:179], v216 offset:9216
    s_waitcnt lgkmcnt(8)
    v_mfma_f32_32x32x16_bf16 v[0:15], v[160:163], v[84:87], v[0:15]
    buffer_load_dwordx4 v227, s[4:7], 0 offen offset:3072 nt lds
    ds_read_b64_tr_b16 v[180:181], v217 offset:8192
    ds_read_b64_tr_b16 v[182:183], v217 offset:9216
    s_waitcnt lgkmcnt(8)
    v_mfma_f32_32x32x16_bf16 v[16:31], v[164:167], v[84:87], v[16:31]
    s_add_u32 m0, s40, 0
    s_nop 0
    ds_read_b64_tr_b16 v[184:185], v218 offset:8192
    ds_read_b64_tr_b16 v[186:187], v218 offset:9216
    s_waitcnt lgkmcnt(8)
    v_mfma_f32_32x32x16_bf16 v[32:47], v[168:171], v[84:87], v[32:47]
    buffer_load_dwordx4 v224, s[4:7], s42 offen offset:0 nt lds
    ds_read_b64_tr_b16 v[188:189], v219 offset:8192
    ds_read_b64_tr_b16 v[190:191], v219 offset:9216
    s_waitcnt lgkmcnt(8)
    v_mfma_f32_32x32x16_bf16 v[48:63], v[172:175], v[84:87], v[48:63]
    buffer_load_dwordx4 v225, s[4:7], s42 offen offset:1024 nt lds
    ds_read_b64_tr_b16 v[192:193], v216 offset:12288
    ds_read_b64_tr_b16 v[194:195], v216 offset:13312
    s_waitcnt lgkmcnt(8)
    v_mfma_f32_32x32x16_bf16 v[0:15], v[176:179], v[88:91], v[0:15]
    buffer_load_dwordx4 v226, s[4:7], s42 offen offset:2048 nt lds
    ds_read_b64_tr_b16 v[196:197], v217 offset:12288
    ds_read_b64_tr_b16 v[198:199], v217 offset:13312
    s_waitcnt lgkmcnt(8)
    v_mfma_f32_32x32x16_bf16 v[16:31], v[180:183], v[88:91], v[16:31]
    buffer_load_dwordx4 v227, s[4:7], s42 offen offset:3072 nt lds
    ds_read_b64_tr_b16 v[200:201], v218 offset:12288
    ds_read_b64_tr_b16 v[202:203], v218 offset:13312
    s_waitcnt lgkmcnt(8)
    v_mfma_f32_32x32x16_bf16 v[32:47], v[184:187], v[88:91], v[32:47]
    ds_read_b64_tr_b16 v[204:205], v219 offset:12288
    ds_read_b64_tr_b16 v[206:207], v219 offset:13312
    s_waitcnt lgkmcnt(8)
    v_mfma_f32_32x32x16_bf16 v[48:63], v[188:191], v[88:91], v[48:63]
    s_waitcnt lgkmcnt(6)
    v_mfma_f32_32x32x16_bf16 v[0:15], v[192:195], v[92:95], v[0:15]
    s_waitcnt lgkmcnt(4)
    v_mfma_f32_32x32x16_bf16 v[16:31], v[196:199], v[92:95], v[16:31]
    s_waitcnt lgkmcnt(2)
    v_mfma_f32_32x32x16_bf16 v[32:47], v[200:203], v[92:95], v[32:47]
    s_waitcnt lgkmcnt(0)
    v_mfma_f32_32x32x16_bf16 v[48:63], v[204:207], v[92:95], v[48:63]
    s_waitcnt vmcnt(8)
    s_barrier
    ds_read_b128 v[64:67], v140 offset:32768
    ds_read_b128 v[68:71], v141 offset:32768
    ds_read_b128 v[72:75], v142 offset:32768
    ds_read_b128 v[76:79], v143 offset:32768
    v_add_u32 v216, 49152, v222
    v_xor_b32 v217, 0x40, v216
    v_xor_b32 v218, 0x80, v216
    v_xor_b32 v219, 0xc0, v216
    ds_read_b64_tr_b16 v[144:145], v216 offset:0
    ds_read_b64_tr_b16 v[146:147], v216 offset:1024
    ds_read_b64_tr_b16 v[148:149], v217 offset:0
    ds_read_b64_tr_b16 v[150:151], v217 offset:1024
    ds_read_b64_tr_b16 v[152:153], v218 offset:0
    ds_read_b64_tr_b16 v[154:155], v218 offset:1024
    ds_read_b64_tr_b16 v[156:157], v219 offset:0
    ds_read_b64_tr_b16 v[158:159], v219 offset:1024
    s_mov_b32 s42, 32768
    ds_read_b64_tr_b16 v[160:161], v216 offset:4096
    ds_read_b64_tr_b16 v[162:163], v216 offset:5120
    s_waitcnt lgkmcnt(8)
    v_mfma_f32_32x32x16_bf16 v[0:15], v[144:147], v[64:67], v[0:15]
    s_add_u32 m0, s40, 16384
    s_nop 0
    ds_read_b64_tr_b16 v[164:165], v217 offset:4096
    ds_read_b64_tr_b16 v[166:167], v217 offset:5120
    s_waitcnt lgkmcnt(8)
    v_mfma_f32_32x32x16_bf16 v[16:31], v[148:151], v[64:67], v[16:31]
    buffer_load_dwordx4 v228, s[8:11], 0 offen offset:0 nt lds
    ds_read_b64_tr_b16 v[168:169], v218 offset:4096
    ds_read_b64_tr_b16 v[170:171], v218 offset:5120
    s_waitcnt lgkmcnt(8)
    v_mfma_f32_32x32x16_bf16 v[32:47], v[152:155], v[64:67], v[32:47]
    buffer_load_dwordx4 v228, s[8:11], 0 offen offset:1024 nt lds
    ds_read_b64_tr_b16 v[172:173], v219 offset:4096
    ds_read_b64_tr_b16 v[174:175], v219 offset:5120
    s_waitcnt lgkmcnt(8)
    v_mfma_f32_32x32x16_bf16 v[48:63], v[156:159], v[64:67], v[48:63]
    buffer_load_dwordx4 v228, s[8:11], 0 offen offset:2048 nt lds
    ds_read_b64_tr_b16 v[176:177], v216 offset:8192
    ds_read_b64_tr_b16 v[178:179], v216 offset:9216
    s_waitcnt lgkmcnt(8)
    v_mfma_f32_32x32x16_bf16 v[0:15], v[160:163], v[68:71], v[0:15]
    buffer_load_dwordx4 v228, s[8:11], 0 offen offset:3072 nt lds
    ds_read_b64_tr_b16 v[180:181], v217 offset:8192
    ds_read_b64_tr_b16 v[182:183], v217 offset:9216
    s_waitcnt lgkmcnt(8)
    v_mfma_f32_32x32x16_bf16 v[16:31], v[164:167], v[68:71], v[16:31]
    s_add_u32 m0, s40, 32768
    s_nop 0
    ds_read_b64_tr_b16 v[184:185], v218 offset:8192
    ds_read_b64_tr_b16 v[186:187], v218 offset:9216
    s_waitcnt lgkmcnt(8)
    v_mfma_f32_32x32x16_bf16 v[32:47], v[168:171], v[68:71], v[32:47]
    buffer_load_dwordx4 v224, s[4:7], s42 offen offset:0 nt lds
    ds_read_b64_tr_b16 v[188:189], v219 offset:8192
    ds_read_b64_tr_b16 v[190:191], v219 offset:9216
    s_waitcnt lgkmcnt(8)
    v_mfma_f32_32x32x16_bf16 v[48:63], v[172:175], v[68:71], v[48:63]
    buffer_load_dwordx4 v225, s[4:7], s42 offen offset:1024 nt lds
    ds_read_b64_tr_b16 v[192:193], v216 offset:12288
    ds_read_b64_tr_b16 v[194:195], v216 offset:13312
    s_waitcnt lgkmcnt(8)
    v_mfma_f32_32x32x16_bf16 v[0:15], v[176:179], v[72:75], v[0:15]
    buffer_load_dwordx4 v226, s[4:7], s42 offen offset:2048 nt lds
    ds_read_b64_tr_b16 v[196:197], v217 offset:12288
    ds_read_b64_tr_b16 v[198:199], v217 offset:13312
    s_waitcnt lgkmcnt(8)
    v_mfma_f32_32x32x16_bf16 v[16:31], v[180:183], v[72:75], v[16:31]
    buffer_load_dwordx4 v227, s[4:7], s42 offen offset:3072 nt lds
    ds_read_b64_tr_b16 v[200:201], v218 offset:12288
    ds_read_b64_tr_b16 v[202:203], v218 offset:13312
    s_waitcnt lgkmcnt(8)
    v_mfma_f32_32x32x16_bf16 v[32:47], v[184:187], v[72:75], v[32:47]
    ds_read_b64_tr_b16 v[204:205], v219 offset:12288
    ds_read_b64_tr_b16 v[206:207], v219 offset:13312
    s_waitcnt lgkmcnt(8)
    v_mfma_f32_32x32x16_bf16 v[48:63], v[188:191], v[72:75], v[48:63]
    s_waitcnt lgkmcnt(6)
    v_mfma_f32_32x32x16_bf16 v[0:15], v[192:195], v[76:79], v[0:15]
    s_waitcnt lgkmcnt(4)
    v_mfma_f32_32x32x16_bf16 v[16:31], v[196:199], v[76:79], v[16:31]
    s_waitcnt lgkmcnt(2)
    v_mfma_f32_32x32x16_bf16 v[32:47], v[200:203], v[76:79], v[32:47]
    s_waitcnt lgkmcnt(0)
    v_mfma_f32_32x32x16_bf16 v[48:63], v[204:207], v[76:79], v[48:63]
    v_cmp_eq_u32 vcc, 0, v236
    s_cbranch_vccz K1_RDY
K1_P2:
    s_sleep 16
    global_load_dword v236, v231, s[52:53] offset:128 sc1
    s_waitcnt vmcnt(0)
    v_cmp_eq_u32 vcc, 0, v236
    s_cbranch_vccnz K1_P2
K1_RDY:
    s_nop 7
    s_nop 4
    v_cvt_pk_bf16_f32 v64, v0, v1
    v_cvt_pk_bf16_f32 v65, v2, v3
    v_cvt_pk_bf16_f32 v66, v4, v5
    v_cvt_pk_bf16_f32 v67, v6, v7
    v_cvt_pk_bf16_f32 v68, v8, v9
    v_cvt_pk_bf16_f32 v69, v10, v11
    v_cvt_pk_bf16_f32 v70, v12, v13
    v_cvt_pk_bf16_f32 v71, v14, v15
    v_cvt_pk_bf16_f32 v72, v16, v17
    v_cvt_pk_bf16_f32 v73, v18, v19
    v_cvt_pk_bf16_f32 v74, v20, v21
    v_cvt_pk_bf16_f32 v75, v22, v23
    v_cvt_pk_bf16_f32 v76, v24, v25
    v_cvt_pk_bf16_f32 v77, v26, v27
    v_cvt_pk_bf16_f32 v78, v28, v29
    v_cvt_pk_bf16_f32 v79, v30, v31
    v_cvt_pk_bf16_f32 v80, v32, v33
    v_cvt_pk_bf16_f32 v81, v34, v35
    v_cvt_pk_bf16_f32 v82, v36, v37
    v_cvt_pk_bf16_f32 v83, v38, v39
    v_cvt_pk_bf16_f32 v84, v40, v41
    v_cvt_pk_bf16_f32 v85, v42, v43
    v_cvt_pk_bf16_f32 v86, v44, v45
    v_cvt_pk_bf16_f32 v87, v46, v47
    v_cvt_pk_bf16_f32 v88, v48, v49
    v_cvt_pk_bf16_f32 v89, v50, v51
    v_cvt_pk_bf16_f32 v90, v52, v53
    v_cvt_pk_bf16_f32 v91, v54, v55
    v_cvt_pk_bf16_f32 v92, v56, v57
    v_cvt_pk_bf16_f32 v93, v58, v59
    v_cvt_pk_bf16_f32 v94, v60, v61
    v_cvt_pk_bf16_f32 v95, v62, v63
    v_mov_b32 v0, 0
    v_mov_b32 v1, 0
    v_mov_b32 v2, 0
    v_mov_b32 v3, 0
    v_mov_b32 v4, 0
    v_mov_b32 v5, 0
    v_mov_b32 v6, 0
    v_mov_b32 v7, 0
    v_mov_b32 v8, 0
    v_mov_b32 v9, 0
    v_mov_b32 v10, 0
    v_mov_b32 v11, 0
    v_mov_b32 v12, 0
    v_mov_b32 v13, 0
    v_mov_b32 v14, 0
    v_mov_b32 v15, 0
    v_mov_b32 v16, 0
    v_mov_b32 v17, 0
    v_mov_b32 v18, 0
    v_mov_b32 v19, 0
    v_mov_b32 v20, 0
    v_mov_b32 v21, 0
    v_mov_b32 v22, 0
    v_mov_b32 v23, 0
    v_mov_b32 v24, 0
    v_mov_b32 v25, 0
    v_mov_b32 v26, 0
    v_mov_b32 v27, 0
    v_mov_b32 v28, 0
    v_mov_b32 v29, 0
    v_mov_b32 v30, 0
    v_mov_b32 v31, 0
    v_mov_b32 v32, 0
    v_mov_b32 v33, 0
    v_mov_b32 v34, 0
    v_mov_b32 v35, 0
    v_mov_b32 v36, 0
    v_mov_b32 v37, 0
    v_mov_b32 v38, 0
    v_mov_b32 v39, 0
    v_mov_b32 v40, 0
    v_mov_b32 v41, 0
    v_mov_b32 v42, 0
    v_mov_b32 v43, 0
    v_mov_b32 v44, 0
    v_mov_b32 v45, 0
    v_mov_b32 v46, 0
    v_mov_b32 v47, 0
    v_mov_b32 v48, 0
    v_mov_b32 v49, 0
    v_mov_b32 v50, 0
    v_mov_b32 v51, 0
    v_mov_b32 v52, 0
    v_mov_b32 v53, 0
    v_mov_b32 v54, 0
    v_mov_b32 v55, 0
    v_mov_b32 v56, 0
    v_mov_b32 v57, 0
    v_mov_b32 v58, 0
    v_mov_b32 v59, 0
    v_mov_b32 v60, 0
    v_mov_b32 v61, 0
    v_mov_b32 v62, 0
    v_mov_b32 v63, 0
    v_mov_b32 v232, 0xff800000
    v_mov_b32 v238, 0
    v_mov_b32 v239, 0
    v_mov_b32 v233, 0xff800000
    s_mov_b32 s43, 49152
    s_mov_b32 s46, 16384
    s_mov_b32 s47, 6
    s_cmp_lt_u32 s2, 256
    s_cbranch_scc1 K1_PA
    s_setprio 2
K1_PA:
    s_mov_b32 s45, s43
    s_add_u32 s43, s43, 16384
    s_cmp_eq_u32 s43, 81920
    s_cselect_b32 s43, 0, s43
    s_waitcnt vmcnt(12) lgkmcnt(0)
    s_barrier
    v_add_u32 v208, s43, v220
    ds_read_b128 v[144:147], v208 offset:0
    v_xor_b32 v209, 0x20, v208
    ds_read_b128 v[148:151], v209 offset:0
    v_xor_b32 v210, 0x40, v208
    ds_read_b128 v[152:155], v210 offset:0
    v_xor_b32 v211, 0x60, v208
    ds_read_b128 v[156:159], v211 offset:0
    v_xor_b32 v212, 0x80, v208
    ds_read_b128 v[160:163], v212 offset:0
    v_xor_b32 v213, 0xa0, v208
    ds_read_b128 v[164:167], v213 offset:0
    s_waitcnt lgkmcnt(5)
    v_mfma_f32_32x32x16_bf16 v[96:111], v[144:147], v[64:67], 0
    v_xor_b32 v214, 0xc0, v208
    ds_read_b128 v[168:171], v214 offset:0
    s_add_u32 m0, s40, s45
    s_nop 0
    buffer_load_dwordx4 v228, s[8:11], s46 offen offset:0 nt lds
    s_waitcnt lgkmcnt(5)
    v_mfma_f32_32x32x16_bf16 v[96:111], v[148:151], v[68:71], v[96:111]
    v_xor_b32 v215, 0xe0, v208
    ds_read_b128 v[172:175], v215 offset:0
    s_waitcnt lgkmcnt(5)
    v_mfma_f32_32x32x16_bf16 v[96:111], v[152:155], v[72:75], v[96:111]
    ds_read_b128 v[144:147], v208 offset:8192
    buffer_load_dwordx4 v228, s[8:11], s46 offen offset:1024 nt lds
    s_waitcnt lgkmcnt(5)
    v_mfma_f32_32x32x16_bf16 v[96:111], v[156:159], v[76:79], v[96:111]
    ds_read_b128 v[148:151], v209 offset:8192
    s_waitcnt lgkmcnt(5)
    v_mfma_f32_32x32x16_bf16 v[96:111], v[160:163], v[80:83], v[96:111]
    ds_read_b128 v[152:155], v210 offset:8192
    buffer_load_dwordx4 v228, s[8:11], s46 offen offset:2048 nt lds
    s_waitcnt lgkmcnt(5)
    v_mfma_f32_32x32x16_bf16 v[96:111], v[164:167], v[84:87], v[96:111]
    ds_read_b128 v[156:159], v211 offset:8192
    s_waitcnt lgkmcnt(5)
    v_mfma_f32_32x32x16_bf16 v[96:111], v[168:171], v[88:91], v[96:111]
    ds_read_b128 v[160:163], v212 offset:8192
    buffer_load_dwordx4 v228, s[8:11], s46 offen offset:3072 nt lds
    s_waitcnt lgkmcnt(5)
    v_mfma_f32_32x32x16_bf16 v[96:111], v[172:175], v[92:95], v[96:111]
    ds_read_b128 v[164:167], v213 offset:8192
    s_waitcnt lgkmcnt(5)
    v_mfma_f32_32x32x16_bf16 v[112:127], v[144:147], v[64:67], 0
    ds_read_b128 v[168:171], v214 offset:8192
    s_waitcnt lgkmcnt(5)
    v_mfma_f32_32x32x16_bf16 v[112:127], v[148:151], v[68:71], v[112:127]
    ds_read_b128 v[172:175], v215 offset:8192
    s_waitcnt lgkmcnt(5)
    v_mfma_f32_32x32x16_bf16 v[112:127], v[152:155], v[72:75], v[112:127]
    s_waitcnt lgkmcnt(4)
    v_mfma_f32_32x32x16_bf16 v[112:127], v[156:159], v[76:79], v[112:127]
    s_mov_b32 s45, s43
    s_add_u32 s43, s43, 16384
    s_cmp_eq_u32 s43, 81920
    s_cselect_b32 s43, 0, s43
    s_waitcnt vmcnt(12) lgkmcnt(0)
    s_barrier
    v_add_u32 v208, s43, v220
    ds_read_b128 v[144:147], v208 offset:0
    v_xor_b32 v209, 0x20, v208
    ds_read_b128 v[148:151], v209 offset:0
    v_mfma_f32_32x32x16_bf16 v[112:127], v[160:163], v[80:83], v[112:127]
    v_xor_b32 v210, 0x40, v208
    ds_read_b128 v[152:155], v210 offset:0
    v_xor_b32 v211, 0x60, v208
    ds_read_b128 v[156:159], v211 offset:0
    v_mfma_f32_32x32x16_bf16 v[112:127], v[164:167], v[84:87], v[112:127]
    v_xor_b32 v212, 0x80, v208
    ds_read_b128 v[160:163], v212 offset:0
    v_mfma_f32_32x32x16_bf16 v[112:127], v[168:171], v[88:91], v[112:127]
    v_xor_b32 v213, 0xa0, v208
    ds_read_b128 v[164:167], v213 offset:0
    v_mfma_f32_32x32x16_bf16 v[112:127], v[172:175], v[92:95], v[112:127]
    s_nop 7
    s_nop 7
    v_max3_f32 v240, v96, v97, v98
    v_max3_f32 v241, v99, v100, v232
    v_max3_f32 v240, v240, v101, v102
    v_max3_f32 v241, v241, v103, v104
    v_max3_f32 v240, v240, v105, v106
    v_max3_f32 v241, v241, v107, v108
    v_max3_f32 v240, v240, v109, v110
    v_max3_f32 v241, v241, v111, v112
    v_max3_f32 v240, v240, v113, v114
    v_max3_f32 v241, v241, v115, v116
    v_max3_f32 v240, v240, v117, v118
    v_max3_f32 v241, v241, v119, v120
    v_max3_f32 v240, v240, v121, v122
    v_max3_f32 v241, v241, v123, v124
    v_max3_f32 v240, v240, v125, v126
    v_max3_f32 v240, v240, v241, v127
    v_cmp_nle_f32 vcc, v240, v233
    s_cbranch_vccnz K1_RS0
K1_RB0:
    s_lshr_b32 s3, s2, 8
    s_or_b32 s3, s3, s36
    s_cselect_b32 s50, -1, 5
K1_LOOP:
    s_add_u32 s46, s46, 16384
    s_add_u32 s44, s46, 16384
    s_waitcnt lgkmcnt(5)
    v_mfma_f32_32x32x16_bf16 v[176:191], v[144:147], v[64:67], 0
    v_xor_b32 v214, 0xc0, v208
    ds_read_b128 v[168:171], v214 offset:0
    s_add_u32 m0, s40, s45
    s_nop 0
    buffer_load_dwordx4 v224, s[4:7], s44 offen offset:0 nt lds
    v_fma_f32 v96, v96, v242, -v234
    v_fma_f32 v97, v97, v242, -v234
    v_fma_f32 v98, v98, v242, -v234
    v_fma_f32 v99, v99, v242, -v234
    v_exp_f32 v96, v96
    s_waitcnt lgkmcnt(5)
    v_mfma_f32_32x32x16_bf16 v[176:191], v[148:151], v[68:71], v[176:191]
    v_xor_b32 v215, 0xe0, v208
    ds_read_b128 v[172:175], v215 offset:0
    v_exp_f32 v97, v97
    v_exp_f32 v98, v98
    v_exp_f32 v99, v99
    s_waitcnt lgkmcnt(5)
    v_mfma_f32_32x32x16_bf16 v[176:191], v[152:155], v[72:75], v[176:191]
    ds_read_b128 v[144:147], v208 offset:8192
    buffer_load_dwordx4 v225, s[4:7], s44 offen offset:1024 nt lds
    v_fma_f32 v100, v100, v242, -v234
    v_fma_f32 v101, v101, v242, -v234
    v_fma_f32 v102, v102, v242, -v234
    v_fma_f32 v103, v103, v242, -v234
    s_waitcnt lgkmcnt(5)
    v_mfma_f32_32x32x16_bf16 v[176:191], v[156:159], v[76:79], v[176:191]
    ds_read_b128 v[148:151], v209 offset:8192
    v_cvt_pk_bf16_f32 v128, v96, v97
    v_cvt_pk_bf16_f32 v129, v98, v99
    v_exp_f32 v100, v100
    v_exp_f32 v101, v101
    s_waitcnt lgkmcnt(5)
    v_mfma_f32_32x32x16_bf16 v[176:191], v[160:163], v[80:83], v[176:191]
    ds_read_b128 v[152:155], v210 offset:8192
    buffer_load_dwordx4 v226, s[4:7], s44 offen offset:2048 nt lds
    v_exp_f32 v102, v102
    v_exp_f32 v103, v103
    s_waitcnt lgkmcnt(5)
    v_mfma_f32_32x32x16_bf16 v[176:191], v[164:167], v[84:87], v[176:191]
    ds_read_b128 v[156:159], v211 offset:8192
    v_fma_f32 v104, v104, v242, -v234
    v_fma_f32 v105, v105, v242, -v234
    v_fma_f32 v106, v106, v242, -v234
    v_fma_f32 v107, v107, v242, -v234
    v_cvt_pk_bf16_f32 v130, v100, v101
    s_waitcnt lgkmcnt(5)
    v_mfma_f32_32x32x16_bf16 v[176:191], v[168:171], v[88:91], v[176:191]
    ds_read_b128 v[160:163], v212 offset:8192
    buffer_load_dwordx4 v227, s[4:7], s44 offen offset:3072 nt lds
    v_cvt_pk_bf16_f32 v131, v102, v103
    v_exp_f32 v104, v104
    v_exp_f32 v105, v105
    s_waitcnt lgkmcnt(5)
    v_mfma_f32_32x32x16_bf16 v[176:191], v[172:175], v[92:95], v[176:191]
    ds_read_b128 v[164:167], v213 offset:8192
    v_exp_f32 v106, v106
    v_exp_f32 v107, v107
    v_fma_f32 v108, v108, v242, -v234
    s_waitcnt lgkmcnt(5)
    v_mfma_f32_32x32x16_bf16 v[192:207], v[144:147], v[64:67], 0
    ds_read_b128 v[168:171], v214 offset:8192
    v_fma_f32 v109, v109, v242, -v234
    v_fma_f32 v110, v110, v242, -v234
    v_fma_f32 v111, v111, v242, -v234
    v_cvt_pk_bf16_f32 v132, v104, v105
    v_cvt_pk_bf16_f32 v133, v106, v107
    v_exp_f32 v108, v108
    s_waitcnt lgkmcnt(5)
    v_mfma_f32_32x32x16_bf16 v[192:207], v[148:151], v[68:71], v[192:207]
    ds_read_b128 v[172:175], v215 offset:8192
    v_exp_f32 v109, v109
    v_exp_f32 v110, v110
    s_waitcnt lgkmcnt(5)
    v_mfma_f32_32x32x16_bf16 v[192:207], v[152:155], v[72:75], v[192:207]
    v_exp_f32 v111, v111
    v_fma_f32 v112, v112, v242, -v234
    v_fma_f32 v113, v113, v242, -v234
    v_fma_f32 v114, v114, v242, -v234
    s_waitcnt lgkmcnt(4)
    v_mfma_f32_32x32x16_bf16 v[192:207], v[156:159], v[76:79], v[192:207]
    s_mov_b32 s45, s43
    s_add_u32 s43, s43, 16384
    s_cmp_eq_u32 s43, 81920
    s_cselect_b32 s43, 0, s43
    s_waitcnt vmcnt(12) lgkmcnt(0)
    s_barrier
    v_add_u32 v216, s43, v221
    ds_read_b64_tr_b16 v[144:145], v216 offset:0
    ds_read_b64_tr_b16 v[146:147], v216 offset:2048
    v_xor_b32 v217, 0x40, v216
    ds_read_b64_tr_b16 v[148:149], v217 offset:0
    ds_read_b64_tr_b16 v[150:151], v217 offset:2048
    v_fma_f32 v115, v115, v242, -v234
    v_cvt_pk_bf16_f32 v134, v108, v109
    v_cvt_pk_bf16_f32 v135, v110, v111
    v_exp_f32 v112, v112
    v_mfma_f32_32x32x16_bf16 v[192:207], v[160:163], v[80:83], v[192:207]
    v_xor_b32 v218, 0x80, v216
    ds_read_b64_tr_b16 v[152:153], v218 offset:0
    ds_read_b64_tr_b16 v[154:155], v218 offset:2048
    v_xor_b32 v219, 0xc0, v216
    ds_read_b64_tr_b16 v[156:157], v219 offset:0
    ds_read_b64_tr_b16 v[158:159], v219 offset:2048
    v_exp_f32 v113, v113
    v_exp_f32 v114, v114
    v_exp_f32 v115, v115
    v_mfma_f32_32x32x16_bf16 v[192:207], v[164:167], v[84:87], v[192:207]
    ds_read_b64_tr_b16 v[160:161], v216 offset:4096
    ds_read_b64_tr_b16 v[162:163], v216 offset:6144
    v_fma_f32 v116, v116, v242, -v234
    v_fma_f32 v117, v117, v242, -v234
    v_fma_f32 v118, v118, v242, -v234
    v_fma_f32 v119, v119, v242, -v234
    v_mfma_f32_32x32x16_bf16 v[192:207], v[168:171], v[88:91], v[192:207]
    ds_read_b64_tr_b16 v[164:165], v217 offset:4096
    ds_read_b64_tr_b16 v[166:167], v217 offset:6144
    v_cvt_pk_bf16_f32 v136, v112, v113
    v_cvt_pk_bf16_f32 v137, v114, v115
    v_exp_f32 v116, v116
    v_exp_f32 v117, v117
    v_mfma_f32_32x32x16_bf16 v[192:207], v[172:175], v[92:95], v[192:207]
    v_exp_f32 v118, v118
    v_exp_f32 v119, v119
    s_waitcnt lgkmcnt(10)
    v_mfma_f32_32x32x16_bf16 v[0:15], v[144:147], v[128:131], v[0:15]
    ds_read_b64_tr_b16 v[168:169], v218 offset:4096
    ds_read_b64_tr_b16 v[170:171], v218 offset:6144
    s_add_u32 m0, s40, s45
    s_nop 0
    buffer_load_dwordx4 v228, s[8:11], s46 offen offset:0 nt lds
    v_fma_f32 v120, v120, v242, -v234
    v_fma_f32 v121, v121, v242, -v234
    v_fma_f32 v122, v122, v242, -v234
    v_fma_f32 v123, v123, v242, -v234
    v_cvt_pk_bf16_f32 v138, v116, v117
    s_waitcnt lgkmcnt(10)
    v_mfma_f32_32x32x16_bf16 v[16:31], v[148:151], v[128:131], v[16:31]
    ds_read_b64_tr_b16 v[172:173], v219 offset:4096
    ds_read_b64_tr_b16 v[174:175], v219 offset:6144
    v_cvt_pk_bf16_f32 v139, v118, v119
    v_exp_f32 v120, v120
    v_exp_f32 v121, v121
    s_waitcnt lgkmcnt(10)
    v_mfma_f32_32x32x16_bf16 v[32:47], v[152:155], v[128:131], v[32:47]
    ds_read_b64_tr_b16 v[144:145], v216 offset:8192
    ds_read_b64_tr_b16 v[146:147], v216 offset:10240
    buffer_load_dwordx4 v228, s[8:11], s46 offen offset:1024 nt lds
    v_exp_f32 v122, v122
    v_exp_f32 v123, v123
    v_fma_f32 v124, v124, v242, -v234
    s_waitcnt lgkmcnt(10)
    v_mfma_f32_32x32x16_bf16 v[48:63], v[156:159], v[128:131], v[48:63]
    ds_read_b64_tr_b16 v[148:149], v217 offset:8192
    ds_read_b64_tr_b16 v[150:151], v217 offset:10240
    v_fma_f32 v125, v125, v242, -v234
    v_fma_f32 v126, v126, v242, -v234
    v_fma_f32 v127, v127, v242, -v234
    v_cvt_pk_bf16_f32 v140, v120, v121
    v_cvt_pk_bf16_f32 v141, v122, v123
    s_waitcnt lgkmcnt(10)
    v_mfma_f32_32x32x16_bf16 v[0:15], v[160:163], v[132:135], v[0:15]
    ds_read_b64_tr_b16 v[152:153], v218 offset:8192
    ds_read_b64_tr_b16 v[154:155], v218 offset:10240
    buffer_load_dwordx4 v228, s[8:11], s46 offen offset:2048 nt lds
    v_exp_f32 v124, v124
    v_exp_f32 v125, v125
    v_exp_f32 v126, v126
    s_waitcnt lgkmcnt(10)
    v_mfma_f32_32x32x16_bf16 v[16:31], v[164:167], v[132:135], v[16:31]
    ds_read_b64_tr_b16 v[156:157], v219 offset:8192
    ds_read_b64_tr_b16 v[158:159], v219 offset:10240
    v_exp_f32 v127, v127
    v_add_f32 v238, v238, v96
    v_cvt_pk_bf16_f32 v142, v124, v125
    s_waitcnt lgkmcnt(10)
    v_mfma_f32_32x32x16_bf16 v[32:47], v[168:171], v[132:135], v[32:47]
    ds_read_b64_tr_b16 v[160:161], v216 offset:12288
    ds_read_b64_tr_b16 v[162:163], v216 offset:14336
    buffer_load_dwordx4 v228, s[8:11], s46 offen offset:3072 nt lds
    v_cvt_pk_bf16_f32 v143, v126, v127
    v_add_f32 v239, v239, v97
    v_add_f32 v238, v238, v98
    v_add_f32 v239, v239, v99
    v_add_f32 v238, v238, v100
    s_waitcnt lgkmcnt(10)
    v_mfma_f32_32x32x16_bf16 v[48:63], v[172:175], v[132:135], v[48:63]
    ds_read_b64_tr_b16 v[164:165], v217 offset:12288
    ds_read_b64_tr_b16 v[166:167], v217 offset:14336
    v_add_f32 v239, v239, v101
    v_add_f32 v238, v238, v102
    v_add_f32 v239, v239, v103
    v_add_f32 v238, v238, v104
    v_add_f32 v239, v239, v105
    s_waitcnt lgkmcnt(10)
    v_mfma_f32_32x32x16_bf16 v[0:15], v[144:147], v[136:139], v[0:15]
    ds_read_b64_tr_b16 v[168:169], v218 offset:12288
    ds_read_b64_tr_b16 v[170:171], v218 offset:14336
    v_add_f32 v238, v238, v106
    v_add_f32 v239, v239, v107
    v_add_f32 v238, v238, v108
    v_add_f32 v239, v239, v109
    v_add_f32 v238, v238, v110
    s_waitcnt lgkmcnt(10)
    v_mfma_f32_32x32x16_bf16 v[16:31], v[148:151], v[136:139], v[16:31]
    ds_read_b64_tr_b16 v[172:173], v219 offset:12288
    ds_read_b64_tr_b16 v[174:175], v219 offset:14336
    v_add_f32 v239, v239, v111
    v_add_f32 v238, v238, v112
    v_add_f32 v239, v239, v113
    v_add_f32 v238, v238, v114
    v_add_f32 v239, v239, v115
    s_waitcnt lgkmcnt(10)
    v_mfma_f32_32x32x16_bf16 v[32:47], v[152:155], v[136:139], v[32:47]
    v_add_f32 v238, v238, v116
    v_add_f32 v239, v239, v117
    v_add_f32 v238, v238, v118
    v_add_f32 v239, v239, v119
    v_add_f32 v238, v238, v120
    s_waitcnt lgkmcnt(8)
    v_mfma_f32_32x32x16_bf16 v[48:63], v[156:159], v[136:139], v[48:63]
    s_mov_b32 s45, s43
    s_add_u32 s43, s43, 16384
    s_cmp_eq_u32 s43, 81920
    s_cselect_b32 s43, 0, s43
    s_waitcnt vmcnt(12) lgkmcnt(0)
    s_barrier
    v_add_u32 v208, s43, v220
    ds_read_b128 v[144:147], v208 offset:0
    v_xor_b32 v209, 0x20, v208
    ds_read_b128 v[148:151], v209 offset:0
    v_add_f32 v239, v239, v121
    v_add_f32 v238, v238, v122
    v_add_f32 v239, v239, v123
    v_add_f32 v238, v238, v124
    v_add_f32 v239, v239, v125
    v_mfma_f32_32x32x16_bf16 v[0:15], v[160:163], v[140:143], v[0:15]
    v_xor_b32 v210, 0x40, v208
    ds_read_b128 v[152:155], v210 offset:0
    v_xor_b32 v211, 0x60, v208
    ds_read_b128 v[156:159], v211 offset:0
    v_add_f32 v238, v238, v126
    v_add_f32 v239, v239, v127
    v_max3_f32 v240, v176, v177, v178
    v_max3_f32 v241, v179, v180, v232
    v_max3_f32 v240, v240, v181, v182
    v_mfma_f32_32x32x16_bf16 v[16:31], v[164:167], v[140:143], v[16:31]
    v_xor_b32 v212, 0x80, v208
    ds_read_b128 v[160:163], v212 offset:0
    v_max3_f32 v241, v241, v183, v184
    v_max3_f32 v240, v240, v185, v186
    v_max3_f32 v241, v241, v187, v188
    v_max3_f32 v240, v240, v189, v190
    v_max3_f32 v241, v241, v191, v192
    v_mfma_f32_32x32x16_bf16 v[32:47], v[168:171], v[140:143], v[32:47]
    v_xor_b32 v213, 0xa0, v208
    ds_read_b128 v[164:167], v213 offset:0
    v_max3_f32 v240, v240, v193, v194
    v_max3_f32 v241, v241, v195, v196
    v_max3_f32 v240, v240, v197, v198
    v_max3_f32 v241, v241, v199, v200
    v_max3_f32 v240, v240, v201, v202
    v_mfma_f32_32x32x16_bf16 v[48:63], v[172:175], v[140:143], v[48:63]
    v_max3_f32 v241, v241, v203, v204
    v_max3_f32 v240, v240, v205, v206
    v_max3_f32 v240, v240, v241, v207
    v_cmp_nle_f32 vcc, v240, v233
    s_cbranch_vccnz K1_RS1
K1_RB1:
    s_add_u32 s46, s46, 16384
    s_add_u32 s44, s46, 16384
    s_waitcnt lgkmcnt(5)
    v_mfma_f32_32x32x16_bf16 v[96:111], v[144:147], v[64:67], 0
    v_xor_b32 v214, 0xc0, v208
    ds_read_b128 v[168:171], v214 offset:0
    s_add_u32 m0, s40, s45
    s_nop 0
    buffer_load_dwordx4 v224, s[4:7], s44 offen offset:0 nt lds
    v_fma_f32 v176, v176, v242, -v234
    v_fma_f32 v177, v177, v242, -v234
    v_fma_f32 v178, v178, v242, -v234
    v_fma_f32 v179, v179, v242, -v234
    v_exp_f32 v176, v176
    s_waitcnt lgkmcnt(5)
    v_mfma_f32_32x32x16_bf16 v[96:111], v[148:151], v[68:71], v[96:111]
    v_xor_b32 v215, 0xe0, v208
    ds_read_b128 v[172:175], v215 offset:0
    v_exp_f32 v177, v177
    v_exp_f32 v178, v178
    v_exp_f32 v179, v179
    s_waitcnt lgkmcnt(5)
    v_mfma_f32_32x32x16_bf16 v[96:111], v[152:155], v[72:75], v[96:111]
    ds_read_b128 v[144:147], v208 offset:8192
    buffer_load_dwordx4 v225, s[4:7], s44 offen offset:1024 nt lds
    v_fma_f32 v180, v180, v242, -v234
    v_fma_f32 v181, v181, v242, -v234
    v_fma_f32 v182, v182, v242, -v234
    v_fma_f32 v183, v183, v242, -v234
    s_waitcnt lgkmcnt(5)
    v_mfma_f32_32x32x16_bf16 v[96:111], v[156:159], v[76:79], v[96:111]
    ds_read_b128 v[148:151], v209 offset:8192
    v_cvt_pk_bf16_f32 v128, v176, v177
    v_cvt_pk_bf16_f32 v129, v178, v179
    v_exp_f32 v180, v180
    v_exp_f32 v181, v181
    s_waitcnt lgkmcnt(5)
    v_mfma_f32_32x32x16_bf16 v[96:111], v[160:163], v[80:83], v[96:111]
    ds_read_b128 v[152:155], v210 offset:8192
    buffer_load_dwordx4 v226, s[4:7], s44 offen offset:2048 nt lds
    v_exp_f32 v182, v182
    v_exp_f32 v183, v183
    s_waitcnt lgkmcnt(5)
    v_mfma_f32_32x32x16_bf16 v[96:111], v[164:167], v[84:87], v[96:111]
    ds_read_b128 v[156:159], v211 offset:8192
    v_fma_f32 v184, v184, v242, -v234
    v_fma_f32 v185, v185, v242, -v234
    v_fma_f32 v186, v186, v242, -v234
    v_fma_f32 v187, v187, v242, -v234
    v_cvt_pk_bf16_f32 v130, v180, v181
    s_waitcnt lgkmcnt(5)
    v_mfma_f32_32x32x16_bf16 v[96:111], v[168:171], v[88:91], v[96:111]
    ds_read_b128 v[160:163], v212 offset:8192
    buffer_load_dwordx4 v227, s[4:7], s44 offen offset:3072 nt lds
    v_cvt_pk_bf16_f32 v131, v182, v183
    v_exp_f32 v184, v184
    v_exp_f32 v185, v185
    s_waitcnt lgkmcnt(5)
    v_mfma_f32_32x32x16_bf16 v[96:111], v[172:175], v[92:95], v[96:111]
    ds_read_b128 v[164:167], v213 offset:8192
    v_exp_f32 v186, v186
    v_exp_f32 v187, v187
    v_fma_f32 v188, v188, v242, -v234
    s_waitcnt lgkmcnt(5)
    v_mfma_f32_32x32x16_bf16 v[112:127], v[144:147], v[64:67], 0
    ds_read_b128 v[168:171], v214 offset:8192
    v_fma_f32 v189, v189, v242, -v234
    v_fma_f32 v190, v190, v242, -v234
    v_fma_f32 v191, v191, v242, -v234
    v_cvt_pk_bf16_f32 v132, v184, v185
    v_cvt_pk_bf16_f32 v133, v186, v187
    v_exp_f32 v188, v188
    s_waitcnt lgkmcnt(5)
    v_mfma_f32_32x32x16_bf16 v[112:127], v[148:151], v[68:71], v[112:127]
    ds_read_b128 v[172:175], v215 offset:8192
    v_exp_f32 v189, v189
    v_exp_f32 v190, v190
    s_waitcnt lgkmcnt(5)
    v_mfma_f32_32x32x16_bf16 v[112:127], v[152:155], v[72:75], v[112:127]
    v_exp_f32 v191, v191
    v_fma_f32 v192, v192, v242, -v234
    v_fma_f32 v193, v193, v242, -v234
    v_fma_f32 v194, v194, v242, -v234
    s_waitcnt lgkmcnt(4)
    v_mfma_f32_32x32x16_bf16 v[112:127], v[156:159], v[76:79], v[112:127]
    s_mov_b32 s45, s43
    s_add_u32 s43, s43, 16384
    s_cmp_eq_u32 s43, 81920
    s_cselect_b32 s43, 0, s43
    s_waitcnt vmcnt(12) lgkmcnt(0)
    s_barrier
    v_add_u32 v216, s43, v221
    ds_read_b64_tr_b16 v[144:145], v216 offset:0
    ds_read_b64_tr_b16 v[146:147], v216 offset:2048
    v_xor_b32 v217, 0x40, v216
    ds_read_b64_tr_b16 v[148:149], v217 offset:0
    ds_read_b64_tr_b16 v[150:151], v217 offset:2048
    v_fma_f32 v195, v195, v242, -v234
    v_cvt_pk_bf16_f32 v134, v188, v189
    v_cvt_pk_bf16_f32 v135, v190, v191
    v_exp_f32 v192, v192
    v_mfma_f32_32x32x16_bf16 v[112:127], v[160:163], v[80:83], v[112:127]
    v_xor_b32 v218, 0x80, v216
    ds_read_b64_tr_b16 v[152:153], v218 offset:0
    ds_read_b64_tr_b16 v[154:155], v218 offset:2048
    v_xor_b32 v219, 0xc0, v216
    ds_read_b64_tr_b16 v[156:157], v219 offset:0
    ds_read_b64_tr_b16 v[158:159], v219 offset:2048
    v_exp_f32 v193, v193
    v_exp_f32 v194, v194
    v_exp_f32 v195, v195
    v_mfma_f32_32x32x16_bf16 v[112:127], v[164:167], v[84:87], v[112:127]
    ds_read_b64_tr_b16 v[160:161], v216 offset:4096
    ds_read_b64_tr_b16 v[162:163], v216 offset:6144
    v_fma_f32 v196, v196, v242, -v234
    v_fma_f32 v197, v197, v242, -v234
    v_fma_f32 v198, v198, v242, -v234
    v_fma_f32 v199, v199, v242, -v234
    v_mfma_f32_32x32x16_bf16 v[112:127], v[168:171], v[88:91], v[112:127]
    ds_read_b64_tr_b16 v[164:165], v217 offset:4096
    ds_read_b64_tr_b16 v[166:167], v217 offset:6144
    v_cvt_pk_bf16_f32 v136, v192, v193
    v_cvt_pk_bf16_f32 v137, v194, v195
    v_exp_f32 v196, v196
    v_exp_f32 v197, v197
    v_mfma_f32_32x32x16_bf16 v[112:127], v[172:175], v[92:95], v[112:127]
    v_exp_f32 v198, v198
    v_exp_f32 v199, v199
    s_waitcnt lgkmcnt(10)
    v_mfma_f32_32x32x16_bf16 v[0:15], v[144:147], v[128:131], v[0:15]
    ds_read_b64_tr_b16 v[168:169], v218 offset:4096
    ds_read_b64_tr_b16 v[170:171], v218 offset:6144
    s_add_u32 m0, s40, s45
    s_nop 0
    buffer_load_dwordx4 v228, s[8:11], s46 offen offset:0 nt lds
    v_fma_f32 v200, v200, v242, -v234
    v_fma_f32 v201, v201, v242, -v234
    v_fma_f32 v202, v202, v242, -v234
    v_fma_f32 v203, v203, v242, -v234
    v_cvt_pk_bf16_f32 v138, v196, v197
    s_waitcnt lgkmcnt(10)
    v_mfma_f32_32x32x16_bf16 v[16:31], v[148:151], v[128:131], v[16:31]
    ds_read_b64_tr_b16 v[172:173], v219 offset:4096
    ds_read_b64_tr_b16 v[174:175], v219 offset:6144
    v_cvt_pk_bf16_f32 v139, v198, v199
    v_exp_f32 v200, v200
    v_exp_f32 v201, v201
    s_waitcnt lgkmcnt(10)
    v_mfma_f32_32x32x16_bf16 v[32:47], v[152:155], v[128:131], v[32:47]
    ds_read_b64_tr_b16 v[144:145], v216 offset:8192
    ds_read_b64_tr_b16 v[146:147], v216 offset:10240
    buffer_load_dwordx4 v228, s[8:11], s46 offen offset:1024 nt lds
    v_exp_f32 v202, v202
    v_exp_f32 v203, v203
    v_fma_f32 v204, v204, v242, -v234
    s_waitcnt lgkmcnt(10)
    v_mfma_f32_32x32x16_bf16 v[48:63], v[156:159], v[128:131], v[48:63]
    ds_read_b64_tr_b16 v[148:149], v217 offset:8192
    ds_read_b64_tr_b16 v[150:151], v217 offset:10240
    v_fma_f32 v205, v205, v242, -v234
    v_fma_f32 v206, v206, v242, -v234
    v_fma_f32 v207, v207, v242, -v234
    v_cvt_pk_bf16_f32 v140, v200, v201
    v_cvt_pk_bf16_f32 v141, v202, v203
    s_waitcnt lgkmcnt(10)
    v_mfma_f32_32x32x16_bf16 v[0:15], v[160:163], v[132:135], v[0:15]
    ds_read_b64_tr_b16 v[152:153], v218 offset:8192
    ds_read_b64_tr_b16 v[154:155], v218 offset:10240
    buffer_load_dwordx4 v228, s[8:11], s46 offen offset:2048 nt lds
    v_exp_f32 v204, v204
    v_exp_f32 v205, v205
    v_exp_f32 v206, v206
    s_waitcnt lgkmcnt(10)
    v_mfma_f32_32x32x16_bf16 v[16:31], v[164:167], v[132:135], v[16:31]
    ds_read_b64_tr_b16 v[156:157], v219 offset:8192
    ds_read_b64_tr_b16 v[158:159], v219 offset:10240
    v_exp_f32 v207, v207
    v_add_f32 v238, v238, v176
    v_cvt_pk_bf16_f32 v142, v204, v205
    s_waitcnt lgkmcnt(10)
    v_mfma_f32_32x32x16_bf16 v[32:47], v[168:171], v[132:135], v[32:47]
    ds_read_b64_tr_b16 v[160:161], v216 offset:12288
    ds_read_b64_tr_b16 v[162:163], v216 offset:14336
    buffer_load_dwordx4 v228, s[8:11], s46 offen offset:3072 nt lds
    v_cvt_pk_bf16_f32 v143, v206, v207
    v_add_f32 v239, v239, v177
    v_add_f32 v238, v238, v178
    v_add_f32 v239, v239, v179
    v_add_f32 v238, v238, v180
    s_waitcnt lgkmcnt(10)
    v_mfma_f32_32x32x16_bf16 v[48:63], v[172:175], v[132:135], v[48:63]
    ds_read_b64_tr_b16 v[164:165], v217 offset:12288
    ds_read_b64_tr_b16 v[166:167], v217 offset:14336
    v_add_f32 v239, v239, v181
    v_add_f32 v238, v238, v182
    v_add_f32 v239, v239, v183
    v_add_f32 v238, v238, v184
    v_add_f32 v239, v239, v185
    s_waitcnt lgkmcnt(10)
    v_mfma_f32_32x32x16_bf16 v[0:15], v[144:147], v[136:139], v[0:15]
    ds_read_b64_tr_b16 v[168:169], v218 offset:12288
    ds_read_b64_tr_b16 v[170:171], v218 offset:14336
    v_add_f32 v238, v238, v186
    v_add_f32 v239, v239, v187
    v_add_f32 v238, v238, v188
    v_add_f32 v239, v239, v189
    v_add_f32 v238, v238, v190
    s_waitcnt lgkmcnt(10)
    v_mfma_f32_32x32x16_bf16 v[16:31], v[148:151], v[136:139], v[16:31]
    ds_read_b64_tr_b16 v[172:173], v219 offset:12288
    ds_read_b64_tr_b16 v[174:175], v219 offset:14336
    v_add_f32 v239, v239, v191
    v_add_f32 v238, v238, v192
    v_add_f32 v239, v239, v193
    v_add_f32 v238, v238, v194
    v_add_f32 v239, v239, v195
    s_waitcnt lgkmcnt(10)
    v_mfma_f32_32x32x16_bf16 v[32:47], v[152:155], v[136:139], v[32:47]
    v_add_f32 v238, v238, v196
    v_add_f32 v239, v239, v197
    v_add_f32 v238, v238, v198
    v_add_f32 v239, v239, v199
    v_add_f32 v238, v238, v200
    s_waitcnt lgkmcnt(8)
    v_mfma_f32_32x32x16_bf16 v[48:63], v[156:159], v[136:139], v[48:63]
    s_mov_b32 s45, s43
    s_add_u32 s43, s43, 16384
    s_cmp_eq_u32 s43, 81920
    s_cselect_b32 s43, 0, s43
    s_waitcnt vmcnt(12) lgkmcnt(0)
    s_barrier
    v_add_u32 v208, s43, v220
    ds_read_b128 v[144:147], v208 offset:0
    v_xor_b32 v209, 0x20, v208
    ds_read_b128 v[148:151], v209 offset:0
    v_add_f32 v239, v239, v201
    v_add_f32 v238, v238, v202
    v_add_f32 v239, v239, v203
    v_add_f32 v238, v238, v204
    v_add_f32 v239, v239, v205
    v_mfma_f32_32x32x16_bf16 v[0:15], v[160:163], v[140:143], v[0:15]
    v_xor_b32 v210, 0x40, v208
    ds_read_b128 v[152:155], v210 offset:0
    v_xor_b32 v211, 0x60, v208
    ds_read_b128 v[156:159], v211 offset:0
    v_add_f32 v238, v238, v206
    v_add_f32 v239, v239, v207
    v_max3_f32 v240, v96, v97, v98
    v_max3_f32 v241, v99, v100, v232
    v_max3_f32 v240, v240, v101, v102
    v_mfma_f32_32x32x16_bf16 v[16:31], v[164:167], v[140:143], v[16:31]
    v_xor_b32 v212, 0x80, v208
    ds_read_b128 v[160:163], v212 offset:0
    v_max3_f32 v241, v241, v103, v104
    v_max3_f32 v240, v240, v105, v106
    v_max3_f32 v241, v241, v107, v108
    v_max3_f32 v240, v240, v109, v110
    v_max3_f32 v241, v241, v111, v112
    v_mfma_f32_32x32x16_bf16 v[32:47], v[168:171], v[140:143], v[32:47]
    v_xor_b32 v213, 0xa0, v208
    ds_read_b128 v[164:167], v213 offset:0
    v_max3_f32 v240, v240, v113, v114
    v_max3_f32 v241, v241, v115, v116
    v_max3_f32 v240, v240, v117, v118
    v_max3_f32 v241, v241, v119, v120
    v_max3_f32 v240, v240, v121, v122
    v_mfma_f32_32x32x16_bf16 v[48:63], v[172:175], v[140:143], v[48:63]
    v_max3_f32 v241, v241, v123, v124
    v_max3_f32 v240, v240, v125, v126
    v_max3_f32 v240, v240, v241, v127
    v_cmp_nle_f32 vcc, v240, v233
    s_cbranch_vccnz K1_RS2
K1_RB2:
    s_sub_u32 s47, s47, 1
    s_cmp_lg_u32 s47, 0
    s_cbranch_scc1 K1_LOOP
    s_add_u32 s46, s46, 16384
    s_add_u32 s44, s46, 16384
    s_waitcnt lgkmcnt(5)
    v_mfma_f32_32x32x16_bf16 v[176:191], v[144:147], v[64:67], 0
    v_xor_b32 v214, 0xc0, v208
    ds_read_b128 v[168:171], v214 offset:0
    s_add_u32 m0, s40, s45
    s_nop 0
    buffer_load_dwordx4 v224, s[4:7], s44 offen offset:0 nt lds
    v_fma_f32 v96, v96, v242, -v234
    v_fma_f32 v97, v97, v242, -v234
    v_fma_f32 v98, v98, v242, -v234
    v_fma_f32 v99, v99, v242, -v234
    v_exp_f32 v96, v96
    s_waitcnt lgkmcnt(5)
    v_mfma_f32_32x32x16_bf16 v[176:191], v[148:151], v[68:71], v[176:191]
    v_xor_b32 v215, 0xe0, v208
    ds_read_b128 v[172:175], v215 offset:0
    v_exp_f32 v97, v97
    v_exp_f32 v98, v98
    v_exp_f32 v99, v99
    s_waitcnt lgkmcnt(5)
    v_mfma_f32_32x32x16_bf16 v[176:191], v[152:155], v[72:75], v[176:191]
    ds_read_b128 v[144:147], v208 offset:8192
    buffer_load_dwordx4 v225, s[4:7], s44 offen offset:1024 nt lds
    v_fma_f32 v100, v100, v242, -v234
    v_fma_f32 v101, v101, v242, -v234
    v_fma_f32 v102, v102, v242, -v234
    v_fma_f32 v103, v103, v242, -v234
    s_waitcnt lgkmcnt(5)
    v_mfma_f32_32x32x16_bf16 v[176:191], v[156:159], v[76:79], v[176:191]
    ds_read_b128 v[148:151], v209 offset:8192
    v_cvt_pk_bf16_f32 v128, v96, v97
    v_cvt_pk_bf16_f32 v129, v98, v99
    v_exp_f32 v100, v100
    v_exp_f32 v101, v101
    s_waitcnt lgkmcnt(5)
    v_mfma_f32_32x32x16_bf16 v[176:191], v[160:163], v[80:83], v[176:191]
    ds_read_b128 v[152:155], v210 offset:8192
    buffer_load_dwordx4 v226, s[4:7], s44 offen offset:2048 nt lds
    v_exp_f32 v102, v102
    v_exp_f32 v103, v103
    s_waitcnt lgkmcnt(5)
    v_mfma_f32_32x32x16_bf16 v[176:191], v[164:167], v[84:87], v[176:191]
    ds_read_b128 v[156:159], v211 offset:8192
    v_fma_f32 v104, v104, v242, -v234
    v_fma_f32 v105, v105, v242, -v234
    v_fma_f32 v106, v106, v242, -v234
    v_fma_f32 v107, v107, v242, -v234
    v_cvt_pk_bf16_f32 v130, v100, v101
    s_waitcnt lgkmcnt(5)
    v_mfma_f32_32x32x16_bf16 v[176:191], v[168:171], v[88:91], v[176:191]
    ds_read_b128 v[160:163], v212 offset:8192
    buffer_load_dwordx4 v227, s[4:7], s44 offen offset:3072 nt lds
    v_cvt_pk_bf16_f32 v131, v102, v103
    v_exp_f32 v104, v104
    v_exp_f32 v105, v105
    s_waitcnt lgkmcnt(5)
    v_mfma_f32_32x32x16_bf16 v[176:191], v[172:175], v[92:95], v[176:191]
    ds_read_b128 v[164:167], v213 offset:8192
    v_exp_f32 v106, v106
    v_exp_f32 v107, v107
    v_fma_f32 v108, v108, v242, -v234
    s_waitcnt lgkmcnt(5)
    v_mfma_f32_32x32x16_bf16 v[192:207], v[144:147], v[64:67], 0
    ds_read_b128 v[168:171], v214 offset:8192
    v_fma_f32 v109, v109, v242, -v234
    v_fma_f32 v110, v110, v242, -v234
    v_fma_f32 v111, v111, v242, -v234
    v_cvt_pk_bf16_f32 v132, v104, v105
    v_cvt_pk_bf16_f32 v133, v106, v107
    v_exp_f32 v108, v108
    s_waitcnt lgkmcnt(5)
    v_mfma_f32_32x32x16_bf16 v[192:207], v[148:151], v[68:71], v[192:207]
    ds_read_b128 v[172:175], v215 offset:8192
    v_exp_f32 v109, v109
    v_exp_f32 v110, v110
    s_waitcnt lgkmcnt(5)
    v_mfma_f32_32x32x16_bf16 v[192:207], v[152:155], v[72:75], v[192:207]
    v_exp_f32 v111, v111
    v_fma_f32 v112, v112, v242, -v234
    v_fma_f32 v113, v113, v242, -v234
    v_fma_f32 v114, v114, v242, -v234
    s_waitcnt lgkmcnt(4)
    v_mfma_f32_32x32x16_bf16 v[192:207], v[156:159], v[76:79], v[192:207]
    s_mov_b32 s45, s43
    s_add_u32 s43, s43, 16384
    s_cmp_eq_u32 s43, 81920
    s_cselect_b32 s43, 0, s43
    s_waitcnt vmcnt(12) lgkmcnt(0)
    s_barrier
    v_add_u32 v216, s43, v221
    ds_read_b64_tr_b16 v[144:145], v216 offset:0
    ds_read_b64_tr_b16 v[146:147], v216 offset:2048
    v_xor_b32 v217, 0x40, v216
    ds_read_b64_tr_b16 v[148:149], v217 offset:0
    ds_read_b64_tr_b16 v[150:151], v217 offset:2048
    v_fma_f32 v115, v115, v242, -v234
    v_cvt_pk_bf16_f32 v134, v108, v109
    v_cvt_pk_bf16_f32 v135, v110, v111
    v_exp_f32 v112, v112
    v_mfma_f32_32x32x16_bf16 v[192:207], v[160:163], v[80:83], v[192:207]
    v_xor_b32 v218, 0x80, v216
    ds_read_b64_tr_b16 v[152:153], v218 offset:0
    ds_read_b64_tr_b16 v[154:155], v218 offset:2048
    v_xor_b32 v219, 0xc0, v216
    ds_read_b64_tr_b16 v[156:157], v219 offset:0
    ds_read_b64_tr_b16 v[158:159], v219 offset:2048
    v_exp_f32 v113, v113
    v_exp_f32 v114, v114
    v_exp_f32 v115, v115
    v_mfma_f32_32x32x16_bf16 v[192:207], v[164:167], v[84:87], v[192:207]
    ds_read_b64_tr_b16 v[160:161], v216 offset:4096
    ds_read_b64_tr_b16 v[162:163], v216 offset:6144
    v_fma_f32 v116, v116, v242, -v234
    v_fma_f32 v117, v117, v242, -v234
    v_fma_f32 v118, v118, v242, -v234
    v_fma_f32 v119, v119, v242, -v234
    v_mfma_f32_32x32x16_bf16 v[192:207], v[168:171], v[88:91], v[192:207]
    ds_read_b64_tr_b16 v[164:165], v217 offset:4096
    ds_read_b64_tr_b16 v[166:167], v217 offset:6144
    v_cvt_pk_bf16_f32 v136, v112, v113
    v_cvt_pk_bf16_f32 v137, v114, v115
    v_exp_f32 v116, v116
    v_exp_f32 v117, v117
    v_mfma_f32_32x32x16_bf16 v[192:207], v[172:175], v[92:95], v[192:207]
    v_exp_f32 v118, v118
    v_exp_f32 v119, v119
    s_waitcnt lgkmcnt(10)
    v_mfma_f32_32x32x16_bf16 v[0:15], v[144:147], v[128:131], v[0:15]
    ds_read_b64_tr_b16 v[168:169], v218 offset:4096
    ds_read_b64_tr_b16 v[170:171], v218 offset:6144
    s_add_u32 m0, s40, s45
    s_nop 0
    buffer_load_dwordx4 v228, s[8:11], s46 offen offset:0 nt lds
    v_fma_f32 v120, v120, v242, -v234
    v_fma_f32 v121, v121, v242, -v234
    v_fma_f32 v122, v122, v242, -v234
    v_fma_f32 v123, v123, v242, -v234
    v_cvt_pk_bf16_f32 v138, v116, v117
    s_waitcnt lgkmcnt(10)
    v_mfma_f32_32x32x16_bf16 v[16:31], v[148:151], v[128:131], v[16:31]
    ds_read_b64_tr_b16 v[172:173], v219 offset:4096
    ds_read_b64_tr_b16 v[174:175], v219 offset:6144
    v_cvt_pk_bf16_f32 v139, v118, v119
    v_exp_f32 v120, v120
    v_exp_f32 v121, v121
    s_waitcnt lgkmcnt(10)
    v_mfma_f32_32x32x16_bf16 v[32:47], v[152:155], v[128:131], v[32:47]
    ds_read_b64_tr_b16 v[144:145], v216 offset:8192
    ds_read_b64_tr_b16 v[146:147], v216 offset:10240
    buffer_load_dwordx4 v228, s[8:11], s46 offen offset:1024 nt lds
    v_exp_f32 v122, v122
    v_exp_f32 v123, v123
    v_fma_f32 v124, v124, v242, -v234
    s_waitcnt lgkmcnt(10)
    v_mfma_f32_32x32x16_bf16 v[48:63], v[156:159], v[128:131], v[48:63]
    ds_read_b64_tr_b16 v[148:149], v217 offset:8192
    ds_read_b64_tr_b16 v[150:151], v217 offset:10240
    v_fma_f32 v125, v125, v242, -v234
    v_fma_f32 v126, v126, v242, -v234
    v_fma_f32 v127, v127, v242, -v234
    v_cvt_pk_bf16_f32 v140, v120, v121
    v_cvt_pk_bf16_f32 v141, v122, v123
    s_waitcnt lgkmcnt(10)
    v_mfma_f32_32x32x16_bf16 v[0:15], v[160:163], v[132:135], v[0:15]
    ds_read_b64_tr_b16 v[152:153], v218 offset:8192
    ds_read_b64_tr_b16 v[154:155], v218 offset:10240
    buffer_load_dwordx4 v228, s[8:11], s46 offen offset:2048 nt lds
    v_exp_f32 v124, v124
    v_exp_f32 v125, v125
    v_exp_f32 v126, v126
    s_waitcnt lgkmcnt(10)
    v_mfma_f32_32x32x16_bf16 v[16:31], v[164:167], v[132:135], v[16:31]
    ds_read_b64_tr_b16 v[156:157], v219 offset:8192
    ds_read_b64_tr_b16 v[158:159], v219 offset:10240
    v_exp_f32 v127, v127
    v_add_f32 v238, v238, v96
    v_cvt_pk_bf16_f32 v142, v124, v125
    s_waitcnt lgkmcnt(10)
    v_mfma_f32_32x32x16_bf16 v[32:47], v[168:171], v[132:135], v[32:47]
    ds_read_b64_tr_b16 v[160:161], v216 offset:12288
    ds_read_b64_tr_b16 v[162:163], v216 offset:14336
    buffer_load_dwordx4 v228, s[8:11], s46 offen offset:3072 nt lds
    v_cvt_pk_bf16_f32 v143, v126, v127
    v_add_f32 v239, v239, v97
    v_add_f32 v238, v238, v98
    v_add_f32 v239, v239, v99
    v_add_f32 v238, v238, v100
    s_waitcnt lgkmcnt(10)
    v_mfma_f32_32x32x16_bf16 v[48:63], v[172:175], v[132:135], v[48:63]
    ds_read_b64_tr_b16 v[164:165], v217 offset:12288
    ds_read_b64_tr_b16 v[166:167], v217 offset:14336
    v_add_f32 v239, v239, v101
    v_add_f32 v238, v238, v102
    v_add_f32 v239, v239, v103
    v_add_f32 v238, v238, v104
    v_add_f32 v239, v239, v105
    s_waitcnt lgkmcnt(10)
    v_mfma_f32_32x32x16_bf16 v[0:15], v[144:147], v[136:139], v[0:15]
    ds_read_b64_tr_b16 v[168:169], v218 offset:12288
    ds_read_b64_tr_b16 v[170:171], v218 offset:14336
    v_add_f32 v238, v238, v106
    v_add_f32 v239, v239, v107
    v_add_f32 v238, v238, v108
    v_add_f32 v239, v239, v109
    v_add_f32 v238, v238, v110
    s_waitcnt lgkmcnt(10)
    v_mfma_f32_32x32x16_bf16 v[16:31], v[148:151], v[136:139], v[16:31]
    ds_read_b64_tr_b16 v[172:173], v219 offset:12288
    ds_read_b64_tr_b16 v[174:175], v219 offset:14336
    v_add_f32 v239, v239, v111
    v_add_f32 v238, v238, v112
    v_add_f32 v239, v239, v113
    v_add_f32 v238, v238, v114
    v_add_f32 v239, v239, v115
    s_waitcnt lgkmcnt(10)
    v_mfma_f32_32x32x16_bf16 v[32:47], v[152:155], v[136:139], v[32:47]
    v_add_f32 v238, v238, v116
    v_add_f32 v239, v239, v117
    v_add_f32 v238, v238, v118
    v_add_f32 v239, v239, v119
    v_add_f32 v238, v238, v120
    s_waitcnt lgkmcnt(8)
    v_mfma_f32_32x32x16_bf16 v[48:63], v[156:159], v[136:139], v[48:63]
    s_mov_b32 s45, s43
    s_add_u32 s43, s43, 16384
    s_cmp_eq_u32 s43, 81920
    s_cselect_b32 s43, 0, s43
    s_waitcnt vmcnt(12) lgkmcnt(0)
    s_barrier
    v_add_u32 v208, s43, v220
    ds_read_b128 v[144:147], v208 offset:0
    v_xor_b32 v209, 0x20, v208
    ds_read_b128 v[148:151], v209 offset:0
    v_add_f32 v239, v239, v121
    v_add_f32 v238, v238, v122
    v_add_f32 v239, v239, v123
    v_add_f32 v238, v238, v124
    v_add_f32 v239, v239, v125
    v_mfma_f32_32x32x16_bf16 v[0:15], v[160:163], v[140:143], v[0:15]
    v_xor_b32 v210, 0x40, v208
    ds_read_b128 v[152:155], v210 offset:0
    v_xor_b32 v211, 0x60, v208
    ds_read_b128 v[156:159], v211 offset:0
    v_add_f32 v238, v238, v126
    v_add_f32 v239, v239, v127
    v_max3_f32 v240, v176, v177, v178
    v_max3_f32 v241, v179, v180, v232
    v_max3_f32 v240, v240, v181, v182
    v_mfma_f32_32x32x16_bf16 v[16:31], v[164:167], v[140:143], v[16:31]
    v_xor_b32 v212, 0x80, v208
    ds_read_b128 v[160:163], v212 offset:0
    v_max3_f32 v241, v241, v183, v184
    v_max3_f32 v240, v240, v185, v186
    v_max3_f32 v241, v241, v187, v188
    v_max3_f32 v240, v240, v189, v190
    v_max3_f32 v241, v241, v191, v192
    v_mfma_f32_32x32x16_bf16 v[32:47], v[168:171], v[140:143], v[32:47]
    v_xor_b32 v213, 0xa0, v208
    ds_read_b128 v[164:167], v213 offset:0
    v_max3_f32 v240, v240, v193, v194
    v_max3_f32 v241, v241, v195, v196
    v_max3_f32 v240, v240, v197, v198
    v_max3_f32 v241, v241, v199, v200
    v_max3_f32 v240, v240, v201, v202
    v_mfma_f32_32x32x16_bf16 v[48:63], v[172:175], v[140:143], v[48:63]
    v_max3_f32 v241, v241, v203, v204
    v_max3_f32 v240, v240, v205, v206
    v_max3_f32 v240, v240, v241, v207
    v_cmp_nle_f32 vcc, v240, v233
    s_cbranch_vccnz K1_RS3
K1_RB3:
    s_waitcnt lgkmcnt(5)
    v_mfma_f32_32x32x16_bf16 v[96:111], v[144:147], v[64:67], 0
    v_xor_b32 v214, 0xc0, v208
    ds_read_b128 v[168:171], v214 offset:0
    s_add_u32 m0, s40, s45
    s_nop 0
    buffer_load_dwordx4 v228, s[8:11], s44 offen offset:0 nt lds
    v_fma_f32 v176, v176, v242, -v234
    v_fma_f32 v177, v177, v242, -v234
    v_fma_f32 v178, v178, v242, -v234
    v_fma_f32 v179, v179, v242, -v234
    v_exp_f32 v176, v176
    s_waitcnt lgkmcnt(5)
    v_mfma_f32_32x32x16_bf16 v[96:111], v[148:151], v[68:71], v[96:111]
    v_xor_b32 v215, 0xe0, v208
    ds_read_b128 v[172:175], v215 offset:0
    v_exp_f32 v177, v177
    v_exp_f32 v178, v178
    v_exp_f32 v179, v179
    s_waitcnt lgkmcnt(5)
    v_mfma_f32_32x32x16_bf16 v[96:111], v[152:155], v[72:75], v[96:111]
    ds_read_b128 v[144:147], v208 offset:8192
    buffer_load_dwordx4 v228, s[8:11], s44 offen offset:1024 nt lds
    v_fma_f32 v180, v180, v242, -v234
    v_fma_f32 v181, v181, v242, -v234
    v_fma_f32 v182, v182, v242, -v234
    v_fma_f32 v183, v183, v242, -v234
    s_waitcnt lgkmcnt(5)
    v_mfma_f32_32x32x16_bf16 v[96:111], v[156:159], v[76:79], v[96:111]
    ds_read_b128 v[148:151], v209 offset:8192
    v_cvt_pk_bf16_f32 v128, v176, v177
    v_cvt_pk_bf16_f32 v129, v178, v179
    v_exp_f32 v180, v180
    v_exp_f32 v181, v181
    s_waitcnt lgkmcnt(5)
    v_mfma_f32_32x32x16_bf16 v[96:111], v[160:163], v[80:83], v[96:111]
    ds_read_b128 v[152:155], v210 offset:8192
    buffer_load_dwordx4 v228, s[8:11], s44 offen offset:2048 nt lds
    v_exp_f32 v182, v182
    v_exp_f32 v183, v183
    s_waitcnt lgkmcnt(5)
    v_mfma_f32_32x32x16_bf16 v[96:111], v[164:167], v[84:87], v[96:111]
    ds_read_b128 v[156:159], v211 offset:8192
    v_fma_f32 v184, v184, v242, -v234
    v_fma_f32 v185, v185, v242, -v234
    v_fma_f32 v186, v186, v242, -v234
    v_fma_f32 v187, v187, v242, -v234
    v_cvt_pk_bf16_f32 v130, v180, v181
    s_waitcnt lgkmcnt(5)
    v_mfma_f32_32x32x16_bf16 v[96:111], v[168:171], v[88:91], v[96:111]
    ds_read_b128 v[160:163], v212 offset:8192
    buffer_load_dwordx4 v228, s[8:11], s44 offen offset:3072 nt lds
    v_cvt_pk_bf16_f32 v131, v182, v183
    v_exp_f32 v184, v184
    v_exp_f32 v185, v185
    s_waitcnt lgkmcnt(5)
    v_mfma_f32_32x32x16_bf16 v[96:111], v[172:175], v[92:95], v[96:111]
    ds_read_b128 v[164:167], v213 offset:8192
    v_exp_f32 v186, v186
    v_exp_f32 v187, v187
    v_fma_f32 v188, v188, v242, -v234
    s_waitcnt lgkmcnt(5)
    v_mfma_f32_32x32x16_bf16 v[112:127], v[144:147], v[64:67], 0
    ds_read_b128 v[168:171], v214 offset:8192
    v_fma_f32 v189, v189, v242, -v234
    v_fma_f32 v190, v190, v242, -v234
    v_fma_f32 v191, v191, v242, -v234
    v_cvt_pk_bf16_f32 v132, v184, v185
    v_cvt_pk_bf16_f32 v133, v186, v187
    v_exp_f32 v188, v188
    s_waitcnt lgkmcnt(5)
    v_mfma_f32_32x32x16_bf16 v[112:127], v[148:151], v[68:71], v[112:127]
    ds_read_b128 v[172:175], v215 offset:8192
    v_exp_f32 v189, v189
    v_exp_f32 v190, v190
    s_waitcnt lgkmcnt(5)
    v_mfma_f32_32x32x16_bf16 v[112:127], v[152:155], v[72:75], v[112:127]
    v_exp_f32 v191, v191
    v_fma_f32 v192, v192, v242, -v234
    v_fma_f32 v193, v193, v242, -v234
    v_fma_f32 v194, v194, v242, -v234
    s_waitcnt lgkmcnt(4)
    v_mfma_f32_32x32x16_bf16 v[112:127], v[156:159], v[76:79], v[112:127]
    s_mov_b32 s45, s43
    s_add_u32 s43, s43, 16384
    s_cmp_eq_u32 s43, 81920
    s_cselect_b32 s43, 0, s43
    s_waitcnt vmcnt(12) lgkmcnt(0)
    s_barrier
    v_add_u32 v216, s43, v221
    ds_read_b64_tr_b16 v[144:145], v216 offset:0
    ds_read_b64_tr_b16 v[146:147], v216 offset:2048
    v_xor_b32 v217, 0x40, v216
    ds_read_b64_tr_b16 v[148:149], v217 offset:0
    ds_read_b64_tr_b16 v[150:151], v217 offset:2048
    v_fma_f32 v195, v195, v242, -v234
    v_cvt_pk_bf16_f32 v134, v188, v189
    v_cvt_pk_bf16_f32 v135, v190, v191
    v_exp_f32 v192, v192
    v_mfma_f32_32x32x16_bf16 v[112:127], v[160:163], v[80:83], v[112:127]
    v_xor_b32 v218, 0x80, v216
    ds_read_b64_tr_b16 v[152:153], v218 offset:0
    ds_read_b64_tr_b16 v[154:155], v218 offset:2048
    v_xor_b32 v219, 0xc0, v216
    ds_read_b64_tr_b16 v[156:157], v219 offset:0
    ds_read_b64_tr_b16 v[158:159], v219 offset:2048
    v_exp_f32 v193, v193
    v_exp_f32 v194, v194
    v_exp_f32 v195, v195
    v_mfma_f32_32x32x16_bf16 v[112:127], v[164:167], v[84:87], v[112:127]
    ds_read_b64_tr_b16 v[160:161], v216 offset:4096
    ds_read_b64_tr_b16 v[162:163], v216 offset:6144
    v_fma_f32 v196, v196, v242, -v234
    v_fma_f32 v197, v197, v242, -v234
    v_fma_f32 v198, v198, v242, -v234
    v_fma_f32 v199, v199, v242, -v234
    v_mfma_f32_32x32x16_bf16 v[112:127], v[168:171], v[88:91], v[112:127]
    ds_read_b64_tr_b16 v[164:165], v217 offset:4096
    ds_read_b64_tr_b16 v[166:167], v217 offset:6144
    v_cvt_pk_bf16_f32 v136, v192, v193
    v_cvt_pk_bf16_f32 v137, v194, v195
    v_exp_f32 v196, v196
    v_exp_f32 v197, v197
    v_mfma_f32_32x32x16_bf16 v[112:127], v[172:175], v[92:95], v[112:127]
    v_exp_f32 v198, v198
    v_exp_f32 v199, v199
    s_waitcnt lgkmcnt(10)
    v_mfma_f32_32x32x16_bf16 v[0:15], v[144:147], v[128:131], v[0:15]
    ds_read_b64_tr_b16 v[168:169], v218 offset:4096
    ds_read_b64_tr_b16 v[170:171], v218 offset:6144
    v_fma_f32 v200, v200, v242, -v234
    v_fma_f32 v201, v201, v242, -v234
    v_fma_f32 v202, v202, v242, -v234
    v_fma_f32 v203, v203, v242, -v234
    v_cvt_pk_bf16_f32 v138, v196, v197
    s_waitcnt lgkmcnt(10)
    v_mfma_f32_32x32x16_bf16 v[16:31], v[148:151], v[128:131], v[16:31]
    ds_read_b64_tr_b16 v[172:173], v219 offset:4096
    ds_read_b64_tr_b16 v[174:175], v219 offset:6144
    v_cvt_pk_bf16_f32 v139, v198, v199
    v_exp_f32 v200, v200
    v_exp_f32 v201, v201
    s_waitcnt lgkmcnt(10)
    v_mfma_f32_32x32x16_bf16 v[32:47], v[152:155], v[128:131], v[32:47]
    ds_read_b64_tr_b16 v[144:145], v216 offset:8192
    ds_read_b64_tr_b16 v[146:147], v216 offset:10240
    v_exp_f32 v202, v202
    v_exp_f32 v203, v203
    v_fma_f32 v204, v204, v242, -v234
    s_waitcnt lgkmcnt(10)
    v_mfma_f32_32x32x16_bf16 v[48:63], v[156:159], v[128:131], v[48:63]
    ds_read_b64_tr_b16 v[148:149], v217 offset:8192
    ds_read_b64_tr_b16 v[150:151], v217 offset:10240
    v_fma_f32 v205, v205, v242, -v234
    v_fma_f32 v206, v206, v242, -v234
    v_fma_f32 v207, v207, v242, -v234
    v_cvt_pk_bf16_f32 v140, v200, v201
    v_cvt_pk_bf16_f32 v141, v202, v203
    s_waitcnt lgkmcnt(10)
    v_mfma_f32_32x32x16_bf16 v[0:15], v[160:163], v[132:135], v[0:15]
    ds_read_b64_tr_b16 v[152:153], v218 offset:8192
    ds_read_b64_tr_b16 v[154:155], v218 offset:10240
    v_exp_f32 v204, v204
    v_exp_f32 v205, v205
    v_exp_f32 v206, v206
    s_waitcnt lgkmcnt(10)
    v_mfma_f32_32x32x16_bf16 v[16:31], v[164:167], v[132:135], v[16:31]
    ds_read_b64_tr_b16 v[156:157], v219 offset:8192
    ds_read_b64_tr_b16 v[158:159], v219 offset:10240
    v_exp_f32 v207, v207
    v_add_f32 v238, v238, v176
    v_cvt_pk_bf16_f32 v142, v204, v205
    s_waitcnt lgkmcnt(10)
    v_mfma_f32_32x32x16_bf16 v[32:47], v[168:171], v[132:135], v[32:47]
    ds_read_b64_tr_b16 v[160:161], v216 offset:12288
    ds_read_b64_tr_b16 v[162:163], v216 offset:14336
    v_cvt_pk_bf16_f32 v143, v206, v207
    v_add_f32 v239, v239, v177
    v_add_f32 v238, v238, v178
    v_add_f32 v239, v239, v179
    v_add_f32 v238, v238, v180
    s_waitcnt lgkmcnt(10)
    v_mfma_f32_32x32x16_bf16 v[48:63], v[172:175], v[132:135], v[48:63]
    ds_read_b64_tr_b16 v[164:165], v217 offset:12288
    ds_read_b64_tr_b16 v[166:167], v217 offset:14336
    v_add_f32 v239, v239, v181
    v_add_f32 v238, v238, v182
    v_add_f32 v239, v239, v183
    v_add_f32 v238, v238, v184
    v_add_f32 v239, v239, v185
    s_waitcnt lgkmcnt(10)
    v_mfma_f32_32x32x16_bf16 v[0:15], v[144:147], v[136:139], v[0:15]
    ds_read_b64_tr_b16 v[168:169], v218 offset:12288
    ds_read_b64_tr_b16 v[170:171], v218 offset:14336
    v_add_f32 v238, v238, v186
    v_add_f32 v239, v239, v187
    v_add_f32 v238, v238, v188
    v_add_f32 v239, v239, v189
    v_add_f32 v238, v238, v190
    s_waitcnt lgkmcnt(10)
    v_mfma_f32_32x32x16_bf16 v[16:31], v[148:151], v[136:139], v[16:31]
    ds_read_b64_tr_b16 v[172:173], v219 offset:12288
    ds_read_b64_tr_b16 v[174:175], v219 offset:14336
    v_add_f32 v239, v239, v191
    v_add_f32 v238, v238, v192
    v_add_f32 v239, v239, v193
    v_add_f32 v238, v238, v194
    v_add_f32 v239, v239, v195
    s_waitcnt lgkmcnt(10)
    v_mfma_f32_32x32x16_bf16 v[32:47], v[152:155], v[136:139], v[32:47]
    v_add_f32 v238, v238, v196
    v_add_f32 v239, v239, v197
    v_add_f32 v238, v238, v198
    v_add_f32 v239, v239, v199
    v_add_f32 v238, v238, v200
    s_waitcnt lgkmcnt(8)
    v_mfma_f32_32x32x16_bf16 v[48:63], v[156:159], v[136:139], v[48:63]
    s_mov_b32 s45, s43
    s_add_u32 s43, s43, 16384
    s_cmp_eq_u32 s43, 81920
    s_cselect_b32 s43, 0, s43
    s_waitcnt vmcnt(8) lgkmcnt(0)
    s_barrier
    v_add_u32 v208, s43, v220
    ds_read_b128 v[144:147], v208 offset:0
    v_xor_b32 v209, 0x20, v208
    ds_read_b128 v[148:151], v209 offset:0
    v_add_f32 v239, v239, v201
    v_add_f32 v238, v238, v202
    v_add_f32 v239, v239, v203
    v_add_f32 v238, v238, v204
    v_add_f32 v239, v239, v205
    v_mfma_f32_32x32x16_bf16 v[0:15], v[160:163], v[140:143], v[0:15]
    v_xor_b32 v210, 0x40, v208
    ds_read_b128 v[152:155], v210 offset:0
    v_xor_b32 v211, 0x60, v208
    ds_read_b128 v[156:159], v211 offset:0
    v_add_f32 v238, v238, v206
    v_add_f32 v239, v239, v207
    v_max3_f32 v240, v96, v97, v98
    v_max3_f32 v241, v99, v100, v232
    v_max3_f32 v240, v240, v101, v102
    v_mfma_f32_32x32x16_bf16 v[16:31], v[164:167], v[140:143], v[16:31]
    v_xor_b32 v212, 0x80, v208
    ds_read_b128 v[160:163], v212 offset:0
    v_max3_f32 v241, v241, v103, v104
    v_max3_f32 v240, v240, v105, v106
    v_max3_f32 v241, v241, v107, v108
    v_max3_f32 v240, v240, v109, v110
    v_max3_f32 v241, v241, v111, v112
    v_mfma_f32_32x32x16_bf16 v[32:47], v[168:171], v[140:143], v[32:47]
    v_xor_b32 v213, 0xa0, v208
    ds_read_b128 v[164:167], v213 offset:0
    v_max3_f32 v240, v240, v113, v114
    v_max3_f32 v241, v241, v115, v116
    v_max3_f32 v240, v240, v117, v118
    v_max3_f32 v241, v241, v119, v120
    v_max3_f32 v240, v240, v121, v122
    v_mfma_f32_32x32x16_bf16 v[48:63], v[172:175], v[140:143], v[48:63]
    v_max3_f32 v241, v241, v123, v124
    v_max3_f32 v240, v240, v125, v126
    v_max3_f32 v240, v240, v241, v127
    v_cmp_nle_f32 vcc, v240, v233
    s_cbranch_vccnz K1_RS4
K1_RB4:
    s_waitcnt lgkmcnt(5)
    v_mfma_f32_32x32x16_bf16 v[176:191], v[144:147], v[64:67], 0
    v_xor_b32 v214, 0xc0, v208
    ds_read_b128 v[168:171], v214 offset:0
    v_fma_f32 v96, v96, v242, -v234
    v_fma_f32 v97, v97, v242, -v234
    v_fma_f32 v98, v98, v242, -v234
    v_fma_f32 v99, v99, v242, -v234
    v_exp_f32 v96, v96
    s_waitcnt lgkmcnt(5)
    v_mfma_f32_32x32x16_bf16 v[176:191], v[148:151], v[68:71], v[176:191]
    v_xor_b32 v215, 0xe0, v208
    ds_read_b128 v[172:175], v215 offset:0
    v_exp_f32 v97, v97
    v_exp_f32 v98, v98
    v_exp_f32 v99, v99
    s_waitcnt lgkmcnt(5)
    v_mfma_f32_32x32x16_bf16 v[176:191], v[152:155], v[72:75], v[176:191]
    ds_read_b128 v[144:147], v208 offset:8192
    v_fma_f32 v100, v100, v242, -v234
    v_fma_f32 v101, v101, v242, -v234
    v_fma_f32 v102, v102, v242, -v234
    v_fma_f32 v103, v103, v242, -v234
    s_waitcnt lgkmcnt(5)
    v_mfma_f32_32x32x16_bf16 v[176:191], v[156:159], v[76:79], v[176:191]
    ds_read_b128 v[148:151], v209 offset:8192
    v_cvt_pk_bf16_f32 v128, v96, v97
    v_cvt_pk_bf16_f32 v129, v98, v99
    v_exp_f32 v100, v100
    v_exp_f32 v101, v101
    s_waitcnt lgkmcnt(5)
    v_mfma_f32_32x32x16_bf16 v[176:191], v[160:163], v[80:83], v[176:191]
    ds_read_b128 v[152:155], v210 offset:8192
    v_exp_f32 v102, v102
    v_exp_f32 v103, v103
    s_waitcnt lgkmcnt(5)
    v_mfma_f32_32x32x16_bf16 v[176:191], v[164:167], v[84:87], v[176:191]
    ds_read_b128 v[156:159], v211 offset:8192
    v_fma_f32 v104, v104, v242, -v234
    v_fma_f32 v105, v105, v242, -v234
    v_fma_f32 v106, v106, v242, -v234
    v_fma_f32 v107, v107, v242, -v234
    v_cvt_pk_bf16_f32 v130, v100, v101
    s_waitcnt lgkmcnt(5)
    v_mfma_f32_32x32x16_bf16 v[176:191], v[168:171], v[88:91], v[176:191]
    ds_read_b128 v[160:163], v212 offset:8192
    v_cvt_pk_bf16_f32 v131, v102, v103
    v_exp_f32 v104, v104
    v_exp_f32 v105, v105
    s_waitcnt lgkmcnt(5)
    v_mfma_f32_32x32x16_bf16 v[176:191], v[172:175], v[92:95], v[176:191]
    ds_read_b128 v[164:167], v213 offset:8192
    v_exp_f32 v106, v106
    v_exp_f32 v107, v107
    v_fma_f32 v108, v108, v242, -v234
    s_waitcnt lgkmcnt(5)
    v_mfma_f32_32x32x16_bf16 v[192:207], v[144:147], v[64:67], 0
    ds_read_b128 v[168:171], v214 offset:8192
    v_fma_f32 v109, v109, v242, -v234
    v_fma_f32 v110, v110, v242, -v234
    v_fma_f32 v111, v111, v242, -v234
    v_cvt_pk_bf16_f32 v132, v104, v105
    v_cvt_pk_bf16_f32 v133, v106, v107
    v_exp_f32 v108, v108
    s_waitcnt lgkmcnt(5)
    v_mfma_f32_32x32x16_bf16 v[192:207], v[148:151], v[68:71], v[192:207]
    ds_read_b128 v[172:175], v215 offset:8192
    v_exp_f32 v109, v109
    v_exp_f32 v110, v110
    s_waitcnt lgkmcnt(5)
    v_mfma_f32_32x32x16_bf16 v[192:207], v[152:155], v[72:75], v[192:207]
    v_exp_f32 v111, v111
    v_fma_f32 v112, v112, v242, -v234
    v_fma_f32 v113, v113, v242, -v234
    v_fma_f32 v114, v114, v242, -v234
    s_waitcnt lgkmcnt(4)
    v_mfma_f32_32x32x16_bf16 v[192:207], v[156:159], v[76:79], v[192:207]
    s_mov_b32 s45, s43
    s_add_u32 s43, s43, 16384
    s_cmp_eq_u32 s43, 81920
    s_cselect_b32 s43, 0, s43
    s_waitcnt vmcnt(4) lgkmcnt(0)
    s_barrier
    v_add_u32 v216, s43, v221
    ds_read_b64_tr_b16 v[144:145], v216 offset:0
    ds_read_b64_tr_b16 v[146:147], v216 offset:2048
    v_xor_b32 v217, 0x40, v216
    ds_read_b64_tr_b16 v[148:149], v217 offset:0
    ds_read_b64_tr_b16 v[150:151], v217 offset:2048
    v_fma_f32 v115, v115, v242, -v234
    v_cvt_pk_bf16_f32 v134, v108, v109
    v_cvt_pk_bf16_f32 v135, v110, v111
    v_exp_f32 v112, v112
    v_mfma_f32_32x32x16_bf16 v[192:207], v[160:163], v[80:83], v[192:207]
    v_xor_b32 v218, 0x80, v216
    ds_read_b64_tr_b16 v[152:153], v218 offset:0
    ds_read_b64_tr_b16 v[154:155], v218 offset:2048
    v_xor_b32 v219, 0xc0, v216
    ds_read_b64_tr_b16 v[156:157], v219 offset:0
    ds_read_b64_tr_b16 v[158:159], v219 offset:2048
    v_exp_f32 v113, v113
    v_exp_f32 v114, v114
    v_exp_f32 v115, v115
    v_mfma_f32_32x32x16_bf16 v[192:207], v[164:167], v[84:87], v[192:207]
    ds_read_b64_tr_b16 v[160:161], v216 offset:4096
    ds_read_b64_tr_b16 v[162:163], v216 offset:6144
    v_fma_f32 v116, v116, v242, -v234
    v_fma_f32 v117, v117, v242, -v234
    v_fma_f32 v118, v118, v242, -v234
    v_fma_f32 v119, v119, v242, -v234
    v_mfma_f32_32x32x16_bf16 v[192:207], v[168:171], v[88:91], v[192:207]
    ds_read_b64_tr_b16 v[164:165], v217 offset:4096
    ds_read_b64_tr_b16 v[166:167], v217 offset:6144
    v_cvt_pk_bf16_f32 v136, v112, v113
    v_cvt_pk_bf16_f32 v137, v114, v115
    v_exp_f32 v116, v116
    v_exp_f32 v117, v117
    v_mfma_f32_32x32x16_bf16 v[192:207], v[172:175], v[92:95], v[192:207]
    v_exp_f32 v118, v118
    v_exp_f32 v119, v119
    s_waitcnt lgkmcnt(10)
    v_mfma_f32_32x32x16_bf16 v[0:15], v[144:147], v[128:131], v[0:15]
    ds_read_b64_tr_b16 v[168:169], v218 offset:4096
    ds_read_b64_tr_b16 v[170:171], v218 offset:6144
    v_fma_f32 v120, v120, v242, -v234
    v_fma_f32 v121, v121, v242, -v234
    v_fma_f32 v122, v122, v242, -v234
    v_fma_f32 v123, v123, v242, -v234
    v_cvt_pk_bf16_f32 v138, v116, v117
    s_waitcnt lgkmcnt(10)
    v_mfma_f32_32x32x16_bf16 v[16:31], v[148:151], v[128:131], v[16:31]
    ds_read_b64_tr_b16 v[172:173], v219 offset:4096
    ds_read_b64_tr_b16 v[174:175], v219 offset:6144
    v_cvt_pk_bf16_f32 v139, v118, v119
    v_exp_f32 v120, v120
    v_exp_f32 v121, v121
    s_waitcnt lgkmcnt(10)
    v_mfma_f32_32x32x16_bf16 v[32:47], v[152:155], v[128:131], v[32:47]
    ds_read_b64_tr_b16 v[144:145], v216 offset:8192
    ds_read_b64_tr_b16 v[146:147], v216 offset:10240
    v_exp_f32 v122, v122
    v_exp_f32 v123, v123
    v_fma_f32 v124, v124, v242, -v234
    s_waitcnt lgkmcnt(10)
    v_mfma_f32_32x32x16_bf16 v[48:63], v[156:159], v[128:131], v[48:63]
    ds_read_b64_tr_b16 v[148:149], v217 offset:8192
    ds_read_b64_tr_b16 v[150:151], v217 offset:10240
    v_fma_f32 v125, v125, v242, -v234
    v_fma_f32 v126, v126, v242, -v234
    v_fma_f32 v127, v127, v242, -v234
    v_cvt_pk_bf16_f32 v140, v120, v121
    v_cvt_pk_bf16_f32 v141, v122, v123
    s_waitcnt lgkmcnt(10)
    v_mfma_f32_32x32x16_bf16 v[0:15], v[160:163], v[132:135], v[0:15]
    ds_read_b64_tr_b16 v[152:153], v218 offset:8192
    ds_read_b64_tr_b16 v[154:155], v218 offset:10240
    v_exp_f32 v124, v124
    v_exp_f32 v125, v125
    v_exp_f32 v126, v126
    s_waitcnt lgkmcnt(10)
    v_mfma_f32_32x32x16_bf16 v[16:31], v[164:167], v[132:135], v[16:31]
    ds_read_b64_tr_b16 v[156:157], v219 offset:8192
    ds_read_b64_tr_b16 v[158:159], v219 offset:10240
    v_exp_f32 v127, v127
    v_add_f32 v238, v238, v96
    v_cvt_pk_bf16_f32 v142, v124, v125
    s_waitcnt lgkmcnt(10)
    v_mfma_f32_32x32x16_bf16 v[32:47], v[168:171], v[132:135], v[32:47]
    ds_read_b64_tr_b16 v[160:161], v216 offset:12288
    ds_read_b64_tr_b16 v[162:163], v216 offset:14336
    v_cvt_pk_bf16_f32 v143, v126, v127
    v_add_f32 v239, v239, v97
    v_add_f32 v238, v238, v98
    v_add_f32 v239, v239, v99
    v_add_f32 v238, v238, v100
    s_waitcnt lgkmcnt(10)
    v_mfma_f32_32x32x16_bf16 v[48:63], v[172:175], v[132:135], v[48:63]
    ds_read_b64_tr_b16 v[164:165], v217 offset:12288
    ds_read_b64_tr_b16 v[166:167], v217 offset:14336
    v_add_f32 v239, v239, v101
    v_add_f32 v238, v238, v102
    v_add_f32 v239, v239, v103
    v_add_f32 v238, v238, v104
    v_add_f32 v239, v239, v105
    s_waitcnt lgkmcnt(10)
    v_mfma_f32_32x32x16_bf16 v[0:15], v[144:147], v[136:139], v[0:15]
    ds_read_b64_tr_b16 v[168:169], v218 offset:12288
    ds_read_b64_tr_b16 v[170:171], v218 offset:14336
    v_add_f32 v238, v238, v106
    v_add_f32 v239, v239, v107
    v_add_f32 v238, v238, v108
    v_add_f32 v239, v239, v109
    v_add_f32 v238, v238, v110
    s_waitcnt lgkmcnt(10)
    v_mfma_f32_32x32x16_bf16 v[16:31], v[148:151], v[136:139], v[16:31]
    ds_read_b64_tr_b16 v[172:173], v219 offset:12288
    ds_read_b64_tr_b16 v[174:175], v219 offset:14336
    v_add_f32 v239, v239, v111
    v_add_f32 v238, v238, v112
    v_add_f32 v239, v239, v113
    v_add_f32 v238, v238, v114
    v_add_f32 v239, v239, v115
    s_waitcnt lgkmcnt(10)
    v_mfma_f32_32x32x16_bf16 v[32:47], v[152:155], v[136:139], v[32:47]
    v_add_f32 v238, v238, v116
    v_add_f32 v239, v239, v117
    v_add_f32 v238, v238, v118
    v_add_f32 v239, v239, v119
    v_add_f32 v238, v238, v120
    s_waitcnt lgkmcnt(8)
    v_mfma_f32_32x32x16_bf16 v[48:63], v[156:159], v[136:139], v[48:63]
    s_mov_b32 s45, s43
    s_add_u32 s43, s43, 16384
    s_cmp_eq_u32 s43, 81920
    s_cselect_b32 s43, 0, s43
    s_waitcnt vmcnt(0) lgkmcnt(0)
    s_barrier
    v_add_u32 v216, s43, v221
    ds_read_b64_tr_b16 v[144:145], v216 offset:0
    ds_read_b64_tr_b16 v[146:147], v216 offset:2048
    v_xor_b32 v217, 0x40, v216
    ds_read_b64_tr_b16 v[148:149], v217 offset:0
    ds_read_b64_tr_b16 v[150:151], v217 offset:2048
    v_add_f32 v239, v239, v121
    v_add_f32 v238, v238, v122
    v_add_f32 v239, v239, v123
    v_add_f32 v238, v238, v124
    v_add_f32 v239, v239, v125
    v_mfma_f32_32x32x16_bf16 v[0:15], v[160:163], v[140:143], v[0:15]
    v_xor_b32 v218, 0x80, v216
    ds_read_b64_tr_b16 v[152:153], v218 offset:0
    ds_read_b64_tr_b16 v[154:155], v218 offset:2048
    v_xor_b32 v219, 0xc0, v216
    ds_read_b64_tr_b16 v[156:157], v219 offset:0
    ds_read_b64_tr_b16 v[158:159], v219 offset:2048
    v_add_f32 v238, v238, v126
    v_add_f32 v239, v239, v127
    v_max3_f32 v240, v176, v177, v178
    v_max3_f32 v241, v179, v180, v232
    v_max3_f32 v240, v240, v181, v182
    v_mfma_f32_32x32x16_bf16 v[16:31], v[164:167], v[140:143], v[16:31]
    ds_read_b64_tr_b16 v[160:161], v216 offset:4096
    ds_read_b64_tr_b16 v[162:163], v216 offset:6144
    v_max3_f32 v241, v241, v183, v184
    v_max3_f32 v240, v240, v185, v186
    v_max3_f32 v241, v241, v187, v188
    v_max3_f32 v240, v240, v189, v190
    v_max3_f32 v241, v241, v191, v192
    v_mfma_f32_32x32x16_bf16 v[32:47], v[168:171], v[140:143], v[32:47]
    ds_read_b64_tr_b16 v[164:165], v217 offset:4096
    ds_read_b64_tr_b16 v[166:167], v217 offset:6144
    v_max3_f32 v240, v240, v193, v194
    v_max3_f32 v241, v241, v195, v196
    v_max3_f32 v240, v240, v197, v198
    v_max3_f32 v241, v241, v199, v200
    v_max3_f32 v240, v240, v201, v202
    v_mfma_f32_32x32x16_bf16 v[48:63], v[172:175], v[140:143], v[48:63]
    v_max3_f32 v241, v241, v203, v204
    v_max3_f32 v240, v240, v205, v206
    v_max3_f32 v240, v240, v241, v207
    v_cmp_nle_f32 vcc, v240, v233
    s_cbranch_vccnz K1_RS5
K1_RB5:
    v_fma_f32 v176, v176, v242, -v234
    v_fma_f32 v177, v177, v242, -v234
    v_fma_f32 v178, v178, v242, -v234
    v_fma_f32 v179, v179, v242, -v234
    v_exp_f32 v176, v176
    v_exp_f32 v177, v177
    v_exp_f32 v178, v178
    v_exp_f32 v179, v179
    v_fma_f32 v180, v180, v242, -v234
    v_fma_f32 v181, v181, v242, -v234
    v_fma_f32 v182, v182, v242, -v234
    v_fma_f32 v183, v183, v242, -v234
    v_cvt_pk_bf16_f32 v128, v176, v177
    v_cvt_pk_bf16_f32 v129, v178, v179
    v_exp_f32 v180, v180
    v_exp_f32 v181, v181
    v_exp_f32 v182, v182
    v_exp_f32 v183, v183
    v_fma_f32 v184, v184, v242, -v234
    v_fma_f32 v185, v185, v242, -v234
    v_fma_f32 v186, v186, v242, -v234
    v_fma_f32 v187, v187, v242, -v234
    v_cvt_pk_bf16_f32 v130, v180, v181
    v_cvt_pk_bf16_f32 v131, v182, v183
    v_exp_f32 v184, v184
    v_exp_f32 v185, v185
    v_exp_f32 v186, v186
    v_exp_f32 v187, v187
    v_fma_f32 v188, v188, v242, -v234
    v_fma_f32 v189, v189, v242, -v234
    v_fma_f32 v190, v190, v242, -v234
    v_fma_f32 v191, v191, v242, -v234
    v_cvt_pk_bf16_f32 v132, v184, v185
    v_cvt_pk_bf16_f32 v133, v186, v187
    v_exp_f32 v188, v188
    v_exp_f32 v189, v189
    v_exp_f32 v190, v190
    v_exp_f32 v191, v191
    v_fma_f32 v192, v192, v242, -v234
    v_fma_f32 v193, v193, v242, -v234
    v_fma_f32 v194, v194, v242, -v234
    v_fma_f32 v195, v195, v242, -v234
    v_cvt_pk_bf16_f32 v134, v188, v189
    v_cvt_pk_bf16_f32 v135, v190, v191
    v_exp_f32 v192, v192
    v_exp_f32 v193, v193
    v_exp_f32 v194, v194
    v_exp_f32 v195, v195
    v_fma_f32 v196, v196, v242, -v234
    v_fma_f32 v197, v197, v242, -v234
    v_fma_f32 v198, v198, v242, -v234
    v_fma_f32 v199, v199, v242, -v234
    v_cvt_pk_bf16_f32 v136, v192, v193
    v_cvt_pk_bf16_f32 v137, v194, v195
    v_exp_f32 v196, v196
    v_exp_f32 v197, v197
    v_exp_f32 v198, v198
    v_exp_f32 v199, v199
    s_waitcnt lgkmcnt(10)
    v_mfma_f32_32x32x16_bf16 v[0:15], v[144:147], v[128:131], v[0:15]
    ds_read_b64_tr_b16 v[168:169], v218 offset:4096
    ds_read_b64_tr_b16 v[170:171], v218 offset:6144
    v_fma_f32 v200, v200, v242, -v234
    v_fma_f32 v201, v201, v242, -v234
    v_fma_f32 v202, v202, v242, -v234
    v_fma_f32 v203, v203, v242, -v234
    s_waitcnt lgkmcnt(10)
    v_mfma_f32_32x32x16_bf16 v[16:31], v[148:151], v[128:131], v[16:31]
    ds_read_b64_tr_b16 v[172:173], v219 offset:4096
    ds_read_b64_tr_b16 v[174:175], v219 offset:6144
    v_cvt_pk_bf16_f32 v138, v196, v197
    v_cvt_pk_bf16_f32 v139, v198, v199
    v_exp_f32 v200, v200
    s_waitcnt lgkmcnt(10)
    v_mfma_f32_32x32x16_bf16 v[32:47], v[152:155], v[128:131], v[32:47]
    ds_read_b64_tr_b16 v[144:145], v216 offset:8192
    ds_read_b64_tr_b16 v[146:147], v216 offset:10240
    v_exp_f32 v201, v201
    v_exp_f32 v202, v202
    s_waitcnt lgkmcnt(10)
    v_mfma_f32_32x32x16_bf16 v[48:63], v[156:159], v[128:131], v[48:63]
    ds_read_b64_tr_b16 v[148:149], v217 offset:8192
    ds_read_b64_tr_b16 v[150:151], v217 offset:10240
    v_exp_f32 v203, v203
    v_fma_f32 v204, v204, v242, -v234
    v_fma_f32 v205, v205, v242, -v234
    s_waitcnt lgkmcnt(10)
    v_mfma_f32_32x32x16_bf16 v[0:15], v[160:163], v[132:135], v[0:15]
    ds_read_b64_tr_b16 v[152:153], v218 offset:8192
    ds_read_b64_tr_b16 v[154:155], v218 offset:10240
    v_fma_f32 v206, v206, v242, -v234
    v_fma_f32 v207, v207, v242, -v234
    v_cvt_pk_bf16_f32 v140, v200, v201
    v_cvt_pk_bf16_f32 v141, v202, v203
    s_waitcnt lgkmcnt(10)
    v_mfma_f32_32x32x16_bf16 v[16:31], v[164:167], v[132:135], v[16:31]
    ds_read_b64_tr_b16 v[156:157], v219 offset:8192
    ds_read_b64_tr_b16 v[158:159], v219 offset:10240
    v_exp_f32 v204, v204
    v_exp_f32 v205, v205
    s_waitcnt lgkmcnt(10)
    v_mfma_f32_32x32x16_bf16 v[32:47], v[168:171], v[132:135], v[32:47]
    ds_read_b64_tr_b16 v[160:161], v216 offset:12288
    ds_read_b64_tr_b16 v[162:163], v216 offset:14336
    v_exp_f32 v206, v206
    v_exp_f32 v207, v207
    s_waitcnt lgkmcnt(10)
    v_mfma_f32_32x32x16_bf16 v[48:63], v[172:175], v[132:135], v[48:63]
    ds_read_b64_tr_b16 v[164:165], v217 offset:12288
    ds_read_b64_tr_b16 v[166:167], v217 offset:14336
    v_add_f32 v238, v238, v176
    v_cvt_pk_bf16_f32 v142, v204, v205
    v_cvt_pk_bf16_f32 v143, v206, v207
    s_waitcnt lgkmcnt(10)
    v_mfma_f32_32x32x16_bf16 v[0:15], v[144:147], v[136:139], v[0:15]
    ds_read_b64_tr_b16 v[168:169], v218 offset:12288
    ds_read_b64_tr_b16 v[170:171], v218 offset:14336
    v_add_f32 v239, v239, v177
    v_add_f32 v238, v238, v178
    v_add_f32 v239, v239, v179
    v_add_f32 v238, v238, v180
    s_waitcnt lgkmcnt(10)
    v_mfma_f32_32x32x16_bf16 v[16:31], v[148:151], v[136:139], v[16:31]
    ds_read_b64_tr_b16 v[172:173], v219 offset:12288
    ds_read_b64_tr_b16 v[174:175], v219 offset:14336
    v_add_f32 v239, v239, v181
    v_add_f32 v238, v238, v182
    v_add_f32 v239, v239, v183
    v_add_f32 v238, v238, v184
    s_waitcnt lgkmcnt(10)
    v_mfma_f32_32x32x16_bf16 v[32:47], v[152:155], v[136:139], v[32:47]
    v_add_f32 v239, v239, v185
    v_add_f32 v238, v238, v186
    v_add_f32 v239, v239, v187
    v_add_f32 v238, v238, v188
    s_waitcnt lgkmcnt(8)
    v_mfma_f32_32x32x16_bf16 v[48:63], v[156:159], v[136:139], v[48:63]
    v_add_f32 v239, v239, v189
    v_add_f32 v238, v238, v190
    v_add_f32 v239, v239, v191
    v_add_f32 v238, v238, v192
    s_waitcnt lgkmcnt(6)
    v_mfma_f32_32x32x16_bf16 v[0:15], v[160:163], v[140:143], v[0:15]
    v_add_f32 v239, v239, v193
    v_add_f32 v238, v238, v194
    v_add_f32 v239, v239, v195
    v_add_f32 v238, v238, v196
    s_waitcnt lgkmcnt(4)
    v_mfma_f32_32x32x16_bf16 v[16:31], v[164:167], v[140:143], v[16:31]
    v_add_f32 v239, v239, v197
    v_add_f32 v238, v238, v198
    v_add_f32 v239, v239, v199
    v_add_f32 v238, v238, v200
    s_waitcnt lgkmcnt(2)
    v_mfma_f32_32x32x16_bf16 v[32:47], v[168:171], v[140:143], v[32:47]
    v_add_f32 v239, v239, v201
    v_add_f32 v238, v238, v202
    v_add_f32 v239, v239, v203
    v_add_f32 v238, v238, v204
    s_waitcnt lgkmcnt(0)
    v_mfma_f32_32x32x16_bf16 v[48:63], v[172:175], v[140:143], v[48:63]
    v_add_f32 v239, v239, v205
    v_add_f32 v238, v238, v206
    v_add_f32 v239, v239, v207
    v_add_f32 v240, v238, v239
    v_mov_b32 v241, v240
    s_nop 1
    v_permlane32_swap_b32 v241, v240
    s_nop 1
    v_add_f32 v240, v240, v241
    v_rcp_f32 v236, v240
    s_mov_b32 s42, 4096
    s_nop 7
    v_pk_mul_f32 v[0:1], v[0:1], v[236:237] op_sel_hi:[1,0]
    v_pk_mul_f32 v[2:3], v[2:3], v[236:237] op_sel_hi:[1,0]
    v_pk_mul_f32 v[4:5], v[4:5], v[236:237] op_sel_hi:[1,0]
    v_pk_mul_f32 v[6:7], v[6:7], v[236:237] op_sel_hi:[1,0]
    v_cvt_pk_bf16_f32 v96, v0, v1
    v_cvt_pk_bf16_f32 v97, v2, v3
    v_cvt_pk_bf16_f32 v98, v4, v5
    v_cvt_pk_bf16_f32 v99, v6, v7
    buffer_store_dwordx4 v[96:99], v245, s[20:23], 0 offen offset:0 sc1
    v_pk_mul_f32 v[8:9], v[8:9], v[236:237] op_sel_hi:[1,0]
    v_pk_mul_f32 v[10:11], v[10:11], v[236:237] op_sel_hi:[1,0]
    v_pk_mul_f32 v[12:13], v[12:13], v[236:237] op_sel_hi:[1,0]
    v_pk_mul_f32 v[14:15], v[14:15], v[236:237] op_sel_hi:[1,0]
    v_cvt_pk_bf16_f32 v100, v8, v9
    v_cvt_pk_bf16_f32 v101, v10, v11
    v_cvt_pk_bf16_f32 v102, v12, v13
    v_cvt_pk_bf16_f32 v103, v14, v15
    buffer_store_dwordx4 v[100:103], v245, s[20:23], 0 offen offset:1024 sc1
    v_pk_mul_f32 v[16:17], v[16:17], v[236:237] op_sel_hi:[1,0]
    v_pk_mul_f32 v[18:19], v[18:19], v[236:237] op_sel_hi:[1,0]
    v_pk_mul_f32 v[20:21], v[20:21], v[236:237] op_sel_hi:[1,0]
    v_pk_mul_f32 v[22:23], v[22:23], v[236:237] op_sel_hi:[1,0]
    v_cvt_pk_bf16_f32 v104, v16, v17
    v_cvt_pk_bf16_f32 v105, v18, v19
    v_cvt_pk_bf16_f32 v106, v20, v21
    v_cvt_pk_bf16_f32 v107, v22, v23
    buffer_store_dwordx4 v[104:107], v245, s[20:23], 0 offen offset:2048 sc1
    v_pk_mul_f32 v[24:25], v[24:25], v[236:237] op_sel_hi:[1,0]
    v_pk_mul_f32 v[26:27], v[26:27], v[236:237] op_sel_hi:[1,0]
    v_pk_mul_f32 v[28:29], v[28:29], v[236:237] op_sel_hi:[1,0]
    v_pk_mul_f32 v[30:31], v[30:31], v[236:237] op_sel_hi:[1,0]
    v_cvt_pk_bf16_f32 v108, v24, v25
    v_cvt_pk_bf16_f32 v109, v26, v27
    v_cvt_pk_bf16_f32 v110, v28, v29
    v_cvt_pk_bf16_f32 v111, v30, v31
    buffer_store_dwordx4 v[108:111], v245, s[20:23], 0 offen offset:3072 sc1
    v_pk_mul_f32 v[32:33], v[32:33], v[236:237] op_sel_hi:[1,0]
    v_pk_mul_f32 v[34:35], v[34:35], v[236:237] op_sel_hi:[1,0]
    v_pk_mul_f32 v[36:37], v[36:37], v[236:237] op_sel_hi:[1,0]
    v_pk_mul_f32 v[38:39], v[38:39], v[236:237] op_sel_hi:[1,0]
    v_cvt_pk_bf16_f32 v112, v32, v33
    v_cvt_pk_bf16_f32 v113, v34, v35
    v_cvt_pk_bf16_f32 v114, v36, v37
    v_cvt_pk_bf16_f32 v115, v38, v39
    buffer_store_dwordx4 v[112:115], v245, s[20:23], s42 offen offset:0 sc1
    v_pk_mul_f32 v[40:41], v[40:41], v[236:237] op_sel_hi:[1,0]
    v_pk_mul_f32 v[42:43], v[42:43], v[236:237] op_sel_hi:[1,0]
    v_pk_mul_f32 v[44:45], v[44:45], v[236:237] op_sel_hi:[1,0]
    v_pk_mul_f32 v[46:47], v[46:47], v[236:237] op_sel_hi:[1,0]
    v_cvt_pk_bf16_f32 v116, v40, v41
    v_cvt_pk_bf16_f32 v117, v42, v43
    v_cvt_pk_bf16_f32 v118, v44, v45
    v_cvt_pk_bf16_f32 v119, v46, v47
    buffer_store_dwordx4 v[116:119], v245, s[20:23], s42 offen offset:1024 sc1
    v_pk_mul_f32 v[48:49], v[48:49], v[236:237] op_sel_hi:[1,0]
    v_pk_mul_f32 v[50:51], v[50:51], v[236:237] op_sel_hi:[1,0]
    v_pk_mul_f32 v[52:53], v[52:53], v[236:237] op_sel_hi:[1,0]
    v_pk_mul_f32 v[54:55], v[54:55], v[236:237] op_sel_hi:[1,0]
    v_cvt_pk_bf16_f32 v120, v48, v49
    v_cvt_pk_bf16_f32 v121, v50, v51
    v_cvt_pk_bf16_f32 v122, v52, v53
    v_cvt_pk_bf16_f32 v123, v54, v55
    buffer_store_dwordx4 v[120:123], v245, s[20:23], s42 offen offset:2048 sc1
    v_pk_mul_f32 v[56:57], v[56:57], v[236:237] op_sel_hi:[1,0]
    v_pk_mul_f32 v[58:59], v[58:59], v[236:237] op_sel_hi:[1,0]
    v_pk_mul_f32 v[60:61], v[60:61], v[236:237] op_sel_hi:[1,0]
    v_pk_mul_f32 v[62:63], v[62:63], v[236:237] op_sel_hi:[1,0]
    v_cvt_pk_bf16_f32 v124, v56, v57
    v_cvt_pk_bf16_f32 v125, v58, v59
    v_cvt_pk_bf16_f32 v126, v60, v61
    v_cvt_pk_bf16_f32 v127, v62, v63
    buffer_store_dwordx4 v[124:127], v245, s[20:23], s42 offen offset:3072 sc1
    s_waitcnt vmcnt(0)
    s_barrier
    s_cmp_lg_u32 s36, 0
    s_cbranch_scc1 K1_NS2
    s_mov_b64 exec, 1
    global_store_dword v246, v247, s[56:57] sc1
    s_mov_b64 exec, -1
K1_NS2:
    s_cmp_ge_u32 s2, 256
    s_cbranch_scc1 K1_FLUSH
    s_setprio 0
    s_mov_b32 s32, s36
    s_load_dwordx2 s[24:25], s[0:1], 32
    s_load_dwordx2 s[26:27], s[0:1], 40
    s_load_dwordx2 s[28:29], s[0:1], 56
    s_and_b32 s43, s2, 1
    s_lshl_b32 s3, s43, 5
    s_lshr_b32 s44, s2, 3
    s_add_u32 s3, s3, s44
    s_mul_i32 s31, s3, 9363
    s_lshr_b32 s31, s31, 16
    s_mul_i32 s30, s31, 7
    s_sub_u32 s30, s3, s30
    s_bfe_u32 s45, s2, 0x20001
    s_mul_i32 s45, s45, 7
    s_add_u32 s30, s30, s45
    s_cmp_ge_u32 s3, 63
    s_cbranch_scc1 K1_FLUSH
    s_mul_i32 s47, s30, 37452
    s_lshr_b32 s48, s47, 16
    s_add_u32 s47, s47, 28089
    s_lshr_b32 s47, s47, 16
    s_sub_u32 s47, s47, s48
    v_lshrrev_b32 v166, 4, v244
    v_and_b32 v166, s47, v166
    v_add_lshl_u32 v166, v166, s48, 5
    v_and_b32 v164, 15, v244
    v_add_lshl_u32 v166, v166, v164, 2
    s_lshl_b32 s33, s30, 19
    s_lshl_b32 s34, s32, 15
    s_add_u32 s33, s33, s34
    s_mul_i32 s34, s32, 589824
    s_lshl_b32 s35, s31, 7
    s_add_u32 s34, s34, s35
    s_lshl_b32 s36, s32, 14
    s_waitcnt lgkmcnt(0)
    s_add_u32 s4, s28, s33
    s_addc_u32 s5, s29, 0
    s_mov_b32 s6, 294912
    s_mov_b32 s7, 0x00020000
    s_add_u32 s8, s24, s34
    s_addc_u32 s9, s25, 0
    s_mov_b32 s10, 589824
    s_mov_b32 s11, 0x00020000
    s_sub_u32 s10, s10, s35
    s_mov_b32 s12, s26
    s_mov_b32 s13, s27
    s_mov_b32 s14, 2064384
    s_mov_b32 s15, 0x00020000
    v_lshlrev_b32 v160, 4, v244
    v_lshrrev_b32 v164, 3, v244
    v_mul_u32_u24 v161, 1152, v164
    v_lshrrev_b32 v164, 2, v244
    v_and_b32 v164, 4, v164
    v_and_b32 v165, 7, v244
    v_xor_b32 v164, v164, v165
    v_lshl_add_u32 v161, v164, 4, v161
    s_mul_i32 s40, s31, 2
    s_mul_i32 s41, s30, 1
    s_add_u32 s40, s40, s41
    s_mul_i32 s46, s32, 2
    s_add_u32 s40, s40, s46
    v_lshrrev_b32 v164, 5, v244
    v_lshlrev_b32 v162, 10, v164
    v_bfe_u32 v164, v244, 2, 2
    v_lshl_add_u32 v162, v164, 7, v162
    v_lshrrev_b32 v164, 1, v164
    v_lshl_add_u32 v162, v164, 6, v162
    v_bfe_u32 v164, v244, 4, 1
    v_lshl_add_u32 v162, v164, 5, v162
    v_and_b32 v164, 1, v244
    v_lshl_add_u32 v162, v164, 4, v162
    v_bfe_u32 v164, v244, 1, 1
    v_lshl_add_u32 v162, v164, 3, v162
    v_add_u32 v162, s36, v162
    v_xor_b32 v163, 64, v162
    s_add_u32 s41, s40, 12
    s_and_b32 s41, s41, 7
    s_add_u32 s42, s46, 12
    s_and_b32 s42, s42, 8
    s_or_b32 s41, s41, s42
    s_mul_i32 s42, s41, 36864
    s_lshl_b32 s41, s41, 11
    s_add_u32 m0, s36, 0
    s_add_u32 s37, s42, 0
    buffer_load_dwordx4 v161, s[8:11], s37 offen lds
    s_add_u32 m0, s36, 1024
    s_add_u32 s37, s42, 9216
    buffer_load_dwordx4 v161, s[8:11], s37 offen lds
    s_add_u32 m0, s36, 2048
    s_add_u32 s37, s42, 18432
    buffer_load_dwordx4 v161, s[8:11], s37 offen lds
    s_add_u32 m0, s36, 3072
    s_add_u32 s37, s42, 27648
    buffer_load_dwordx4 v161, s[8:11], s37 offen lds
    s_add_u32 s41, s40, 13
    s_and_b32 s41, s41, 7
    s_add_u32 s42, s46, 13
    s_and_b32 s42, s42, 8
    s_or_b32 s41, s41, s42
    s_mul_i32 s42, s41, 36864
    s_lshl_b32 s41, s41, 11
    s_add_u32 m0, s36, 4096
    s_add_u32 s37, s42, 0
    buffer_load_dwordx4 v161, s[8:11], s37 offen lds
    s_add_u32 m0, s36, 5120
    s_add_u32 s37, s42, 9216
    buffer_load_dwordx4 v161, s[8:11], s37 offen lds
    s_add_u32 m0, s36, 6144
    s_add_u32 s37, s42, 18432
    buffer_load_dwordx4 v161, s[8:11], s37 offen lds
    s_add_u32 m0, s36, 7168
    s_add_u32 s37, s42, 27648
    buffer_load_dwordx4 v161, s[8:11], s37 offen lds
    s_add_u32 s41, s40, 14
    s_and_b32 s41, s41, 7
    s_add_u32 s42, s46, 14
    s_and_b32 s42, s42, 8
    s_or_b32 s41, s41, s42
    s_mul_i32 s42, s41, 36864
    s_lshl_b32 s41, s41, 11
    s_add_u32 m0, s36, 8192
    s_add_u32 s37, s42, 0
    buffer_load_dwordx4 v161, s[8:11], s37 offen lds
    s_add_u32 m0, s36, 9216
    s_add_u32 s37, s42, 9216
    buffer_load_dwordx4 v161, s[8:11], s37 offen lds
    s_add_u32 m0, s36, 10240
    s_add_u32 s37, s42, 18432
    buffer_load_dwordx4 v161, s[8:11], s37 offen lds
    s_add_u32 m0, s36, 11264
    s_add_u32 s37, s42, 27648
    buffer_load_dwordx4 v161, s[8:11], s37 offen lds
    s_add_u32 s41, s40, 15
    s_and_b32 s41, s41, 7
    s_add_u32 s42, s46, 15
    s_and_b32 s42, s42, 8
    s_or_b32 s41, s41, s42
    s_mul_i32 s42, s41, 36864
    s_lshl_b32 s41, s41, 11
    s_add_u32 m0, s36, 12288
    s_add_u32 s37, s42, 0
    buffer_load_dwordx4 v161, s[8:11], s37 offen lds
    s_add_u32 m0, s36, 13312
    s_add_u32 s37, s42, 9216
    buffer_load_dwordx4 v161, s[8:11], s37 offen lds
    s_add_u32 m0, s36, 14336
    s_add_u32 s37, s42, 18432
    buffer_load_dwordx4 v161, s[8:11], s37 offen lds
    s_add_u32 m0, s36, 15360
    s_add_u32 s37, s42, 27648
    buffer_load_dwordx4 v161, s[8:11], s37 offen lds
    s_waitcnt vmcnt(12) lgkmcnt(0)
    ds_read_b64_tr_b16 v[168:169], v162 offset:0
    ds_read_b64_tr_b16 v[170:171], v162 offset:512
    ds_read_b64_tr_b16 v[172:173], v163 offset:0
    ds_read_b64_tr_b16 v[174:175], v163 offset:512
    ds_read_b64_tr_b16 v[176:177], v162 offset:2048
    ds_read_b64_tr_b16 v[178:179], v162 offset:2560
    ds_read_b64_tr_b16 v[180:181], v163 offset:2048
    ds_read_b64_tr_b16 v[182:183], v163 offset:2560
    s_waitcnt vmcnt(8) lgkmcnt(0)
    ds_read_b64_tr_b16 v[184:185], v162 offset:4096
    ds_read_b64_tr_b16 v[186:187], v162 offset:4608
    ds_read_b64_tr_b16 v[188:189], v163 offset:4096
    ds_read_b64_tr_b16 v[190:191], v163 offset:4608
    ds_read_b64_tr_b16 v[192:193], v162 offset:6144
    ds_read_b64_tr_b16 v[194:195], v162 offset:6656
    ds_read_b64_tr_b16 v[196:197], v163 offset:6144
    ds_read_b64_tr_b16 v[198:199], v163 offset:6656
    s_waitcnt vmcnt(4) lgkmcnt(0)
    ds_read_b64_tr_b16 v[200:201], v162 offset:8192
    ds_read_b64_tr_b16 v[202:203], v162 offset:8704
    ds_read_b64_tr_b16 v[204:205], v163 offset:8192
    ds_read_b64_tr_b16 v[206:207], v163 offset:8704
    ds_read_b64_tr_b16 v[208:209], v162 offset:10240
    ds_read_b64_tr_b16 v[210:211], v162 offset:10752
    ds_read_b64_tr_b16 v[212:213], v163 offset:10240
    ds_read_b64_tr_b16 v[214:215], v163 offset:10752
    s_waitcnt vmcnt(0) lgkmcnt(0)
    ds_read_b64_tr_b16 v[216:217], v162 offset:12288
    ds_read_b64_tr_b16 v[218:219], v162 offset:12800
    ds_read_b64_tr_b16 v[220:221], v163 offset:12288
    ds_read_b64_tr_b16 v[222:223], v163 offset:12800
    ds_read_b64_tr_b16 v[224:225], v162 offset:14336
    ds_read_b64_tr_b16 v[226:227], v162 offset:14848
    ds_read_b64_tr_b16 v[228:229], v163 offset:14336
    ds_read_b64_tr_b16 v[230:231], v163 offset:14848
    s_waitcnt lgkmcnt(0)
    s_add_u32 s41, s40, 0
    s_and_b32 s41, s41, 7
    s_add_u32 s42, s46, 0
    s_and_b32 s42, s42, 8
    s_or_b32 s41, s41, s42
    s_mul_i32 s42, s41, 36864
    s_lshl_b32 s41, s41, 11
    s_add_u32 m0, s36, 0
    s_add_u32 s37, s42, 0
    buffer_load_dwordx4 v161, s[8:11], s37 offen lds
    s_add_u32 m0, s36, 1024
    s_add_u32 s37, s42, 9216
    buffer_load_dwordx4 v161, s[8:11], s37 offen lds
    s_add_u32 m0, s36, 2048
    s_add_u32 s37, s42, 18432
    buffer_load_dwordx4 v161, s[8:11], s37 offen lds
    s_add_u32 m0, s36, 3072
    s_add_u32 s37, s42, 27648
    buffer_load_dwordx4 v161, s[8:11], s37 offen lds
    s_add_u32 s41, s40, 1
    s_and_b32 s41, s41, 7
    s_add_u32 s42, s46, 1
    s_and_b32 s42, s42, 8
    s_or_b32 s41, s41, s42
    s_mul_i32 s42, s41, 36864
    s_lshl_b32 s41, s41, 11
    s_add_u32 m0, s36, 4096
    s_add_u32 s37, s42, 0
    buffer_load_dwordx4 v161, s[8:11], s37 offen lds
    s_add_u32 m0, s36, 5120
    s_add_u32 s37, s42, 9216
    buffer_load_dwordx4 v161, s[8:11], s37 offen lds
    s_add_u32 m0, s36, 6144
    s_add_u32 s37, s42, 18432
    buffer_load_dwordx4 v161, s[8:11], s37 offen lds
    s_add_u32 m0, s36, 7168
    s_add_u32 s37, s42, 27648
    buffer_load_dwordx4 v161, s[8:11], s37 offen lds
    s_cmp_lg_u32 s32, 0
    s_cbranch_scc1 K2_GO0
K2_POLL0:
    global_load_dword v164, v166, s[56:57] offset:0 sc1
    s_waitcnt vmcnt(0)
    v_cmp_eq_u32 vcc, 0, v164
    s_cbranch_vccz K2_GO0
    s_sleep 8
    s_branch K2_POLL0
K2_GO0:
    s_barrier
    s_add_u32 s41, s40, 0
    s_and_b32 s41, s41, 7
    s_add_u32 s42, s46, 0
    s_and_b32 s42, s42, 8
    s_or_b32 s41, s41, s42
    s_mul_i32 s42, s41, 36864
    s_lshl_b32 s41, s41, 11
    s_add_u32 s37, s41, 0
    buffer_load_dwordx4 v[64:67], v160, s[4:7], s37 offen offset:0 sc1
    s_add_u32 s37, s41, 262144
    buffer_load_dwordx4 v[68:71], v160, s[4:7], s37 offen offset:0 sc1
    s_add_u32 s37, s41, 0
    buffer_load_dwordx4 v[72:75], v160, s[4:7], s37 offen offset:1024 sc1
    s_add_u32 s37, s41, 262144
    buffer_load_dwordx4 v[76:79], v160, s[4:7], s37 offen offset:1024 sc1
    s_add_u32 s41, s40, 1
    s_and_b32 s41, s41, 7
    s_add_u32 s42, s46, 1
    s_and_b32 s42, s42, 8
    s_or_b32 s41, s41, s42
    s_mul_i32 s42, s41, 36864
    s_lshl_b32 s41, s41, 11
    s_add_u32 s37, s41, 0
    buffer_load_dwordx4 v[80:83], v160, s[4:7], s37 offen offset:0 sc1
    s_add_u32 s37, s41, 262144
    buffer_load_dwordx4 v[84:87], v160, s[4:7], s37 offen offset:0 sc1
    s_add_u32 s37, s41, 0
    buffer_load_dwordx4 v[88:91], v160, s[4:7], s37 offen offset:1024 sc1
    s_add_u32 s37, s41, 262144
    buffer_load_dwordx4 v[92:95], v160, s[4:7], s37 offen offset:1024 sc1
    s_waitcnt vmcnt(4)
    ds_read_b64_tr_b16 v[128:129], v162 offset:0
    ds_read_b64_tr_b16 v[130:131], v162 offset:512
    ds_read_b64_tr_b16 v[132:133], v163 offset:0
    ds_read_b64_tr_b16 v[134:135], v163 offset:512
    ds_read_b64_tr_b16 v[136:137], v162 offset:2048
    ds_read_b64_tr_b16 v[138:139], v162 offset:2560
    ds_read_b64_tr_b16 v[140:141], v163 offset:2048
    ds_read_b64_tr_b16 v[142:143], v163 offset:2560
    s_add_u32 s41, s40, 2
    s_and_b32 s41, s41, 7
    s_add_u32 s42, s46, 2
    s_and_b32 s42, s42, 8
    s_or_b32 s41, s41, s42
    s_mul_i32 s42, s41, 36864
    s_lshl_b32 s41, s41, 11
    s_add_u32 s37, s41, 0
    buffer_load_dwordx4 v[96:99], v160, s[4:7], s37 offen offset:0 sc1
    s_add_u32 s37, s41, 262144
    buffer_load_dwordx4 v[100:103], v160, s[4:7], s37 offen offset:0 sc1
    s_add_u32 s37, s41, 0
    buffer_load_dwordx4 v[104:107], v160, s[4:7], s37 offen offset:1024 sc1
    s_add_u32 s37, s41, 262144
    buffer_load_dwordx4 v[108:111], v160, s[4:7], s37 offen offset:1024 sc1
    s_add_u32 m0, s36, 8192
    s_add_u32 s37, s42, 0
    buffer_load_dwordx4 v161, s[8:11], s37 offen lds
    s_add_u32 m0, s36, 9216
    s_add_u32 s37, s42, 9216
    buffer_load_dwordx4 v161, s[8:11], s37 offen lds
    s_add_u32 m0, s36, 10240
    s_add_u32 s37, s42, 18432
    buffer_load_dwordx4 v161, s[8:11], s37 offen lds
    s_add_u32 m0, s36, 11264
    s_add_u32 s37, s42, 27648
    buffer_load_dwordx4 v161, s[8:11], s37 offen lds
    s_waitcnt lgkmcnt(6)
    v_mfma_f32_32x32x16_bf16 v[0:15], v[128:131], v[64:67], 0
    v_mfma_f32_32x32x16_bf16 v[16:31], v[128:131], v[68:71], 0
    s_waitcnt lgkmcnt(4)
    v_mfma_f32_32x32x16_bf16 v[32:47], v[132:135], v[64:67], 0
    v_mfma_f32_32x32x16_bf16 v[48:63], v[132:135], v[68:71], 0
    s_waitcnt lgkmcnt(2)
    v_mfma_f32_32x32x16_bf16 v[0:15], v[136:139], v[72:75], v[0:15]
    v_mfma_f32_32x32x16_bf16 v[16:31], v[136:139], v[76:79], v[16:31]
    s_waitcnt lgkmcnt(0)
    v_mfma_f32_32x32x16_bf16 v[32:47], v[140:143], v[72:75], v[32:47]
    v_mfma_f32_32x32x16_bf16 v[48:63], v[140:143], v[76:79], v[48:63]
    s_waitcnt vmcnt(8)
    ds_read_b64_tr_b16 v[144:145], v162 offset:4096
    ds_read_b64_tr_b16 v[146:147], v162 offset:4608
    ds_read_b64_tr_b16 v[148:149], v163 offset:4096
    ds_read_b64_tr_b16 v[150:151], v163 offset:4608
    ds_read_b64_tr_b16 v[152:153], v162 offset:6144
    ds_read_b64_tr_b16 v[154:155], v162 offset:6656
    ds_read_b64_tr_b16 v[156:157], v163 offset:6144
    ds_read_b64_tr_b16 v[158:159], v163 offset:6656
    s_add_u32 s41, s40, 3
    s_and_b32 s41, s41, 7
    s_add_u32 s42, s46, 3
    s_and_b32 s42, s42, 8
    s_or_b32 s41, s41, s42
    s_mul_i32 s42, s41, 36864
    s_lshl_b32 s41, s41, 11
    s_add_u32 s37, s41, 0
    buffer_load_dwordx4 v[64:67], v160, s[4:7], s37 offen offset:0 sc1
    s_add_u32 s37, s41, 262144
    buffer_load_dwordx4 v[68:71], v160, s[4:7], s37 offen offset:0 sc1
    s_add_u32 s37, s41, 0
    buffer_load_dwordx4 v[72:75], v160, s[4:7], s37 offen offset:1024 sc1
    s_add_u32 s37, s41, 262144
    buffer_load_dwordx4 v[76:79], v160, s[4:7], s37 offen offset:1024 sc1
    s_add_u32 m0, s36, 0
    s_add_u32 s37, s42, 0
    buffer_load_dwordx4 v161, s[8:11], s37 offen lds
    s_add_u32 m0, s36, 1024
    s_add_u32 s37, s42, 9216
    buffer_load_dwordx4 v161, s[8:11], s37 offen lds
    s_add_u32 m0, s36, 2048
    s_add_u32 s37, s42, 18432
    buffer_load_dwordx4 v161, s[8:11], s37 offen lds
    s_add_u32 m0, s36, 3072
    s_add_u32 s37, s42, 27648
    buffer_load_dwordx4 v161, s[8:11], s37 offen lds
    s_waitcnt lgkmcnt(6)
    v_mfma_f32_32x32x16_bf16 v[0:15], v[144:147], v[80:83], v[0:15]
    v_mfma_f32_32x32x16_bf16 v[16:31], v[144:147], v[84:87], v[16:31]
    s_waitcnt lgkmcnt(4)
    v_mfma_f32_32x32x16_bf16 v[32:47], v[148:151], v[80:83], v[32:47]
    v_mfma_f32_32x32x16_bf16 v[48:63], v[148:151], v[84:87], v[48:63]
    s_waitcnt lgkmcnt(2)
    v_mfma_f32_32x32x16_bf16 v[0:15], v[152:155], v[88:91], v[0:15]
    v_mfma_f32_32x32x16_bf16 v[16:31], v[152:155], v[92:95], v[16:31]
    s_waitcnt lgkmcnt(0)
    v_mfma_f32_32x32x16_bf16 v[32:47], v[156:159], v[88:91], v[32:47]
    v_mfma_f32_32x32x16_bf16 v[48:63], v[156:159], v[92:95], v[48:63]
    s_waitcnt vmcnt(8)
    ds_read_b64_tr_b16 v[128:129], v162 offset:8192
    ds_read_b64_tr_b16 v[130:131], v162 offset:8704
    ds_read_b64_tr_b16 v[132:133], v163 offset:8192
    ds_read_b64_tr_b16 v[134:135], v163 offset:8704
    ds_read_b64_tr_b16 v[136:137], v162 offset:10240
    ds_read_b64_tr_b16 v[138:139], v162 offset:10752
    ds_read_b64_tr_b16 v[140:141], v163 offset:10240
    ds_read_b64_tr_b16 v[142:143], v163 offset:10752
    s_add_u32 s41, s40, 4
    s_and_b32 s41, s41, 7
    s_add_u32 s42, s46, 4
    s_and_b32 s42, s42, 8
    s_or_b32 s41, s41, s42
    s_mul_i32 s42, s41, 36864
    s_lshl_b32 s41, s41, 11
    s_add_u32 s37, s41, 0
    buffer_load_dwordx4 v[80:83], v160, s[4:7], s37 offen offset:0 sc1
    s_add_u32 s37, s41, 262144
    buffer_load_dwordx4 v[84:87], v160, s[4:7], s37 offen offset:0 sc1
    s_add_u32 s37, s41, 0
    buffer_load_dwordx4 v[88:91], v160, s[4:7], s37 offen offset:1024 sc1
    s_add_u32 s37, s41, 262144
    buffer_load_dwordx4 v[92:95], v160, s[4:7], s37 offen offset:1024 sc1
    s_add_u32 m0, s36, 4096
    s_add_u32 s37, s42, 0
    buffer_load_dwordx4 v161, s[8:11], s37 offen lds
    s_add_u32 m0, s36, 5120
    s_add_u32 s37, s42, 9216
    buffer_load_dwordx4 v161, s[8:11], s37 offen lds
    s_add_u32 m0, s36, 6144
    s_add_u32 s37, s42, 18432
    buffer_load_dwordx4 v161, s[8:11], s37 offen lds
    s_add_u32 m0, s36, 7168
    s_add_u32 s37, s42, 27648
    buffer_load_dwordx4 v161, s[8:11], s37 offen lds
    s_waitcnt lgkmcnt(6)
    v_mfma_f32_32x32x16_bf16 v[0:15], v[128:131], v[96:99], v[0:15]
    v_mfma_f32_32x32x16_bf16 v[16:31], v[128:131], v[100:103], v[16:31]
    s_waitcnt lgkmcnt(4)
    v_mfma_f32_32x32x16_bf16 v[32:47], v[132:135], v[96:99], v[32:47]
    v_mfma_f32_32x32x16_bf16 v[48:63], v[132:135], v[100:103], v[48:63]
    s_waitcnt lgkmcnt(2)
    v_mfma_f32_32x32x16_bf16 v[0:15], v[136:139], v[104:107], v[0:15]
    v_mfma_f32_32x32x16_bf16 v[16:31], v[136:139], v[108:111], v[16:31]
    s_waitcnt lgkmcnt(0)
    v_mfma_f32_32x32x16_bf16 v[32:47], v[140:143], v[104:107], v[32:47]
    v_mfma_f32_32x32x16_bf16 v[48:63], v[140:143], v[108:111], v[48:63]
    s_waitcnt vmcnt(8)
    ds_read_b64_tr_b16 v[144:145], v162 offset:0
    ds_read_b64_tr_b16 v[146:147], v162 offset:512
    ds_read_b64_tr_b16 v[148:149], v163 offset:0
    ds_read_b64_tr_b16 v[150:151], v163 offset:512
    ds_read_b64_tr_b16 v[152:153], v162 offset:2048
    ds_read_b64_tr_b16 v[154:155], v162 offset:2560
    ds_read_b64_tr_b16 v[156:157], v163 offset:2048
    ds_read_b64_tr_b16 v[158:159], v163 offset:2560
    s_add_u32 s41, s40, 5
    s_and_b32 s41, s41, 7
    s_add_u32 s42, s46, 5
    s_and_b32 s42, s42, 8
    s_or_b32 s41, s41, s42
    s_mul_i32 s42, s41, 36864
    s_lshl_b32 s41, s41, 11
    s_add_u32 s37, s41, 0
    buffer_load_dwordx4 v[96:99], v160, s[4:7], s37 offen offset:0 sc1
    s_add_u32 s37, s41, 262144
    buffer_load_dwordx4 v[100:103], v160, s[4:7], s37 offen offset:0 sc1
    s_add_u32 s37, s41, 0
    buffer_load_dwordx4 v[104:107], v160, s[4:7], s37 offen offset:1024 sc1
    s_add_u32 s37, s41, 262144
    buffer_load_dwordx4 v[108:111], v160, s[4:7], s37 offen offset:1024 sc1
    s_add_u32 m0, s36, 8192
    s_add_u32 s37, s42, 0
    buffer_load_dwordx4 v161, s[8:11], s37 offen lds
    s_add_u32 m0, s36, 9216
    s_add_u32 s37, s42, 9216
    buffer_load_dwordx4 v161, s[8:11], s37 offen lds
    s_add_u32 m0, s36, 10240
    s_add_u32 s37, s42, 18432
    buffer_load_dwordx4 v161, s[8:11], s37 offen lds
    s_add_u32 m0, s36, 11264
    s_add_u32 s37, s42, 27648
    buffer_load_dwordx4 v161, s[8:11], s37 offen lds
    s_waitcnt lgkmcnt(6)
    v_mfma_f32_32x32x16_bf16 v[0:15], v[144:147], v[64:67], v[0:15]
    v_mfma_f32_32x32x16_bf16 v[16:31], v[144:147], v[68:71], v[16:31]
    s_waitcnt lgkmcnt(4)
    v_mfma_f32_32x32x16_bf16 v[32:47], v[148:151], v[64:67], v[32:47]
    v_mfma_f32_32x32x16_bf16 v[48:63], v[148:151], v[68:71], v[48:63]
    s_waitcnt lgkmcnt(2)
    v_mfma_f32_32x32x16_bf16 v[0:15], v[152:155], v[72:75], v[0:15]
    v_mfma_f32_32x32x16_bf16 v[16:31], v[152:155], v[76:79], v[16:31]
    s_waitcnt lgkmcnt(0)
    v_mfma_f32_32x32x16_bf16 v[32:47], v[156:159], v[72:75], v[32:47]
    v_mfma_f32_32x32x16_bf16 v[48:63], v[156:159], v[76:79], v[48:63]
    s_waitcnt vmcnt(8)
    ds_read_b64_tr_b16 v[128:129], v162 offset:4096
    ds_read_b64_tr_b16 v[130:131], v162 offset:4608
    ds_read_b64_tr_b16 v[132:133], v163 offset:4096
    ds_read_b64_tr_b16 v[134:135], v163 offset:4608
    ds_read_b64_tr_b16 v[136:137], v162 offset:6144
    ds_read_b64_tr_b16 v[138:139], v162 offset:6656
    ds_read_b64_tr_b16 v[140:141], v163 offset:6144
    ds_read_b64_tr_b16 v[142:143], v163 offset:6656
    s_add_u32 s41, s40, 6
    s_and_b32 s41, s41, 7
    s_add_u32 s42, s46, 6
    s_and_b32 s42, s42, 8
    s_or_b32 s41, s41, s42
    s_mul_i32 s42, s41, 36864
    s_lshl_b32 s41, s41, 11
    s_add_u32 s37, s41, 0
    buffer_load_dwordx4 v[64:67], v160, s[4:7], s37 offen offset:0 sc1
    s_add_u32 s37, s41, 262144
    buffer_load_dwordx4 v[68:71], v160, s[4:7], s37 offen offset:0 sc1
    s_add_u32 s37, s41, 0
    buffer_load_dwordx4 v[72:75], v160, s[4:7], s37 offen offset:1024 sc1
    s_add_u32 s37, s41, 262144
    buffer_load_dwordx4 v[76:79], v160, s[4:7], s37 offen offset:1024 sc1
    s_add_u32 m0, s36, 0
    s_add_u32 s37, s42, 0
    buffer_load_dwordx4 v161, s[8:11], s37 offen lds
    s_add_u32 m0, s36, 1024
    s_add_u32 s37, s42, 9216
    buffer_load_dwordx4 v161, s[8:11], s37 offen lds
    s_add_u32 m0, s36, 2048
    s_add_u32 s37, s42, 18432
    buffer_load_dwordx4 v161, s[8:11], s37 offen lds
    s_add_u32 m0, s36, 3072
    s_add_u32 s37, s42, 27648
    buffer_load_dwordx4 v161, s[8:11], s37 offen lds
    s_waitcnt lgkmcnt(6)
    v_mfma_f32_32x32x16_bf16 v[0:15], v[128:131], v[80:83], v[0:15]
    v_mfma_f32_32x32x16_bf16 v[16:31], v[128:131], v[84:87], v[16:31]
    s_waitcnt lgkmcnt(4)
    v_mfma_f32_32x32x16_bf16 v[32:47], v[132:135], v[80:83], v[32:47]
    v_mfma_f32_32x32x16_bf16 v[48:63], v[132:135], v[84:87], v[48:63]
    s_waitcnt lgkmcnt(2)
    v_mfma_f32_32x32x16_bf16 v[0:15], v[136:139], v[88:91], v[0:15]
    v_mfma_f32_32x32x16_bf16 v[16:31], v[136:139], v[92:95], v[16:31]
    s_waitcnt lgkmcnt(0)
    v_mfma_f32_32x32x16_bf16 v[32:47], v[140:143], v[88:91], v[32:47]
    v_mfma_f32_32x32x16_bf16 v[48:63], v[140:143], v[92:95], v[48:63]
    s_waitcnt vmcnt(8)
    ds_read_b64_tr_b16 v[144:145], v162 offset:8192
    ds_read_b64_tr_b16 v[146:147], v162 offset:8704
    ds_read_b64_tr_b16 v[148:149], v163 offset:8192
    ds_read_b64_tr_b16 v[150:151], v163 offset:8704
    ds_read_b64_tr_b16 v[152:153], v162 offset:10240
    ds_read_b64_tr_b16 v[154:155], v162 offset:10752
    ds_read_b64_tr_b16 v[156:157], v163 offset:10240
    ds_read_b64_tr_b16 v[158:159], v163 offset:10752
    s_add_u32 s41, s40, 7
    s_and_b32 s41, s41, 7
    s_add_u32 s42, s46, 7
    s_and_b32 s42, s42, 8
    s_or_b32 s41, s41, s42
    s_mul_i32 s42, s41, 36864
    s_lshl_b32 s41, s41, 11
    s_add_u32 s37, s41, 0
    buffer_load_dwordx4 v[80:83], v160, s[4:7], s37 offen offset:0 sc1
    s_add_u32 s37, s41, 262144
    buffer_load_dwordx4 v[84:87], v160, s[4:7], s37 offen offset:0 sc1
    s_add_u32 s37, s41, 0
    buffer_load_dwordx4 v[88:91], v160, s[4:7], s37 offen offset:1024 sc1
    s_add_u32 s37, s41, 262144
    buffer_load_dwordx4 v[92:95], v160, s[4:7], s37 offen offset:1024 sc1
    s_add_u32 m0, s36, 4096
    s_add_u32 s37, s42, 0
    buffer_load_dwordx4 v161, s[8:11], s37 offen lds
    s_add_u32 m0, s36, 5120
    s_add_u32 s37, s42, 9216
    buffer_load_dwordx4 v161, s[8:11], s37 offen lds
    s_add_u32 m0, s36, 6144
    s_add_u32 s37, s42, 18432
    buffer_load_dwordx4 v161, s[8:11], s37 offen lds
    s_add_u32 m0, s36, 7168
    s_add_u32 s37, s42, 27648
    buffer_load_dwordx4 v161, s[8:11], s37 offen lds
    s_waitcnt lgkmcnt(6)
    v_mfma_f32_32x32x16_bf16 v[0:15], v[144:147], v[96:99], v[0:15]
    v_mfma_f32_32x32x16_bf16 v[16:31], v[144:147], v[100:103], v[16:31]
    s_waitcnt lgkmcnt(4)
    v_mfma_f32_32x32x16_bf16 v[32:47], v[148:151], v[96:99], v[32:47]
    v_mfma_f32_32x32x16_bf16 v[48:63], v[148:151], v[100:103], v[48:63]
    s_waitcnt lgkmcnt(2)
    v_mfma_f32_32x32x16_bf16 v[0:15], v[152:155], v[104:107], v[0:15]
    v_mfma_f32_32x32x16_bf16 v[16:31], v[152:155], v[108:111], v[16:31]
    s_waitcnt lgkmcnt(0)
    v_mfma_f32_32x32x16_bf16 v[32:47], v[156:159], v[104:107], v[32:47]
    v_mfma_f32_32x32x16_bf16 v[48:63], v[156:159], v[108:111], v[48:63]
    s_waitcnt vmcnt(8)
    ds_read_b64_tr_b16 v[128:129], v162 offset:0
    ds_read_b64_tr_b16 v[130:131], v162 offset:512
    ds_read_b64_tr_b16 v[132:133], v163 offset:0
    ds_read_b64_tr_b16 v[134:135], v163 offset:512
    ds_read_b64_tr_b16 v[136:137], v162 offset:2048
    ds_read_b64_tr_b16 v[138:139], v162 offset:2560
    ds_read_b64_tr_b16 v[140:141], v163 offset:2048
    ds_read_b64_tr_b16 v[142:143], v163 offset:2560
    s_add_u32 s41, s40, 8
    s_and_b32 s41, s41, 7
    s_add_u32 s42, s46, 8
    s_and_b32 s42, s42, 8
    s_or_b32 s41, s41, s42
    s_mul_i32 s42, s41, 36864
    s_lshl_b32 s41, s41, 11
    s_add_u32 s37, s41, 0
    buffer_load_dwordx4 v[96:99], v160, s[4:7], s37 offen offset:0 sc1
    s_add_u32 s37, s41, 262144
    buffer_load_dwordx4 v[100:103], v160, s[4:7], s37 offen offset:0 sc1
    s_add_u32 s37, s41, 0
    buffer_load_dwordx4 v[104:107], v160, s[4:7], s37 offen offset:1024 sc1
    s_add_u32 s37, s41, 262144
    buffer_load_dwordx4 v[108:111], v160, s[4:7], s37 offen offset:1024 sc1
    s_add_u32 m0, s36, 8192
    s_add_u32 s37, s42, 0
    buffer_load_dwordx4 v161, s[8:11], s37 offen lds
    s_add_u32 m0, s36, 9216
    s_add_u32 s37, s42, 9216
    buffer_load_dwordx4 v161, s[8:11], s37 offen lds
    s_add_u32 m0, s36, 10240
    s_add_u32 s37, s42, 18432
    buffer_load_dwordx4 v161, s[8:11], s37 offen lds
    s_add_u32 m0, s36, 11264
    s_add_u32 s37, s42, 27648
    buffer_load_dwordx4 v161, s[8:11], s37 offen lds
    s_waitcnt lgkmcnt(6)
    v_mfma_f32_32x32x16_bf16 v[0:15], v[128:131], v[64:67], v[0:15]
    v_mfma_f32_32x32x16_bf16 v[16:31], v[128:131], v[68:71], v[16:31]
    s_waitcnt lgkmcnt(4)
    v_mfma_f32_32x32x16_bf16 v[32:47], v[132:135], v[64:67], v[32:47]
    v_mfma_f32_32x32x16_bf16 v[48:63], v[132:135], v[68:71], v[48:63]
    s_waitcnt lgkmcnt(2)
    v_mfma_f32_32x32x16_bf16 v[0:15], v[136:139], v[72:75], v[0:15]
    v_mfma_f32_32x32x16_bf16 v[16:31], v[136:139], v[76:79], v[16:31]
    s_waitcnt lgkmcnt(0)
    v_mfma_f32_32x32x16_bf16 v[32:47], v[140:143], v[72:75], v[32:47]
    v_mfma_f32_32x32x16_bf16 v[48:63], v[140:143], v[76:79], v[48:63]
    s_waitcnt vmcnt(8)
    ds_read_b64_tr_b16 v[144:145], v162 offset:4096
    ds_read_b64_tr_b16 v[146:147], v162 offset:4608
    ds_read_b64_tr_b16 v[148:149], v163 offset:4096
    ds_read_b64_tr_b16 v[150:151], v163 offset:4608
    ds_read_b64_tr_b16 v[152:153], v162 offset:6144
    ds_read_b64_tr_b16 v[154:155], v162 offset:6656
    ds_read_b64_tr_b16 v[156:157], v163 offset:6144
    ds_read_b64_tr_b16 v[158:159], v163 offset:6656
    s_add_u32 s41, s40, 9
    s_and_b32 s41, s41, 7
    s_add_u32 s42, s46, 9
    s_and_b32 s42, s42, 8
    s_or_b32 s41, s41, s42
    s_mul_i32 s42, s41, 36864
    s_lshl_b32 s41, s41, 11
    s_add_u32 s37, s41, 0
    buffer_load_dwordx4 v[64:67], v160, s[4:7], s37 offen offset:0 sc1
    s_add_u32 s37, s41, 262144
    buffer_load_dwordx4 v[68:71], v160, s[4:7], s37 offen offset:0 sc1
    s_add_u32 s37, s41, 0
    buffer_load_dwordx4 v[72:75], v160, s[4:7], s37 offen offset:1024 sc1
    s_add_u32 s37, s41, 262144
    buffer_load_dwordx4 v[76:79], v160, s[4:7], s37 offen offset:1024 sc1
    s_add_u32 m0, s36, 0
    s_add_u32 s37, s42, 0
    buffer_load_dwordx4 v161, s[8:11], s37 offen lds
    s_add_u32 m0, s36, 1024
    s_add_u32 s37, s42, 9216
    buffer_load_dwordx4 v161, s[8:11], s37 offen lds
    s_add_u32 m0, s36, 2048
    s_add_u32 s37, s42, 18432
    buffer_load_dwordx4 v161, s[8:11], s37 offen lds
    s_add_u32 m0, s36, 3072
    s_add_u32 s37, s42, 27648
    buffer_load_dwordx4 v161, s[8:11], s37 offen lds
    s_waitcnt lgkmcnt(6)
    v_mfma_f32_32x32x16_bf16 v[0:15], v[144:147], v[80:83], v[0:15]
    v_mfma_f32_32x32x16_bf16 v[16:31], v[144:147], v[84:87], v[16:31]
    s_waitcnt lgkmcnt(4)
    v_mfma_f32_32x32x16_bf16 v[32:47], v[148:151], v[80:83], v[32:47]
    v_mfma_f32_32x32x16_bf16 v[48:63], v[148:151], v[84:87], v[48:63]
    s_waitcnt lgkmcnt(2)
    v_mfma_f32_32x32x16_bf16 v[0:15], v[152:155], v[88:91], v[0:15]
    v_mfma_f32_32x32x16_bf16 v[16:31], v[152:155], v[92:95], v[16:31]
    s_waitcnt lgkmcnt(0)
    v_mfma_f32_32x32x16_bf16 v[32:47], v[156:159], v[88:91], v[32:47]
    v_mfma_f32_32x32x16_bf16 v[48:63], v[156:159], v[92:95], v[48:63]
    s_waitcnt vmcnt(8)
    ds_read_b64_tr_b16 v[128:129], v162 offset:8192
    ds_read_b64_tr_b16 v[130:131], v162 offset:8704
    ds_read_b64_tr_b16 v[132:133], v163 offset:8192
    ds_read_b64_tr_b16 v[134:135], v163 offset:8704
    ds_read_b64_tr_b16 v[136:137], v162 offset:10240
    ds_read_b64_tr_b16 v[138:139], v162 offset:10752
    ds_read_b64_tr_b16 v[140:141], v163 offset:10240
    ds_read_b64_tr_b16 v[142:143], v163 offset:10752
    s_add_u32 s41, s40, 10
    s_and_b32 s41, s41, 7
    s_add_u32 s42, s46, 10
    s_and_b32 s42, s42, 8
    s_or_b32 s41, s41, s42
    s_mul_i32 s42, s41, 36864
    s_lshl_b32 s41, s41, 11
    s_add_u32 s37, s41, 0
    buffer_load_dwordx4 v[80:83], v160, s[4:7], s37 offen offset:0 sc1
    s_add_u32 s37, s41, 262144
    buffer_load_dwordx4 v[84:87], v160, s[4:7], s37 offen offset:0 sc1
    s_add_u32 s37, s41, 0
    buffer_load_dwordx4 v[88:91], v160, s[4:7], s37 offen offset:1024 sc1
    s_add_u32 s37, s41, 262144
    buffer_load_dwordx4 v[92:95], v160, s[4:7], s37 offen offset:1024 sc1
    s_add_u32 m0, s36, 4096
    s_add_u32 s37, s42, 0
    buffer_load_dwordx4 v161, s[8:11], s37 offen lds
    s_add_u32 m0, s36, 5120
    s_add_u32 s37, s42, 9216
    buffer_load_dwordx4 v161, s[8:11], s37 offen lds
    s_add_u32 m0, s36, 6144
    s_add_u32 s37, s42, 18432
    buffer_load_dwordx4 v161, s[8:11], s37 offen lds
    s_add_u32 m0, s36, 7168
    s_add_u32 s37, s42, 27648
    buffer_load_dwordx4 v161, s[8:11], s37 offen lds
    s_waitcnt lgkmcnt(6)
    v_mfma_f32_32x32x16_bf16 v[0:15], v[128:131], v[96:99], v[0:15]
    v_mfma_f32_32x32x16_bf16 v[16:31], v[128:131], v[100:103], v[16:31]
    s_waitcnt lgkmcnt(4)
    v_mfma_f32_32x32x16_bf16 v[32:47], v[132:135], v[96:99], v[32:47]
    v_mfma_f32_32x32x16_bf16 v[48:63], v[132:135], v[100:103], v[48:63]
    s_waitcnt lgkmcnt(2)
    v_mfma_f32_32x32x16_bf16 v[0:15], v[136:139], v[104:107], v[0:15]
    v_mfma_f32_32x32x16_bf16 v[16:31], v[136:139], v[108:111], v[16:31]
    s_waitcnt lgkmcnt(0)
    v_mfma_f32_32x32x16_bf16 v[32:47], v[140:143], v[104:107], v[32:47]
    v_mfma_f32_32x32x16_bf16 v[48:63], v[140:143], v[108:111], v[48:63]
    s_waitcnt vmcnt(8)
    ds_read_b64_tr_b16 v[144:145], v162 offset:0
    ds_read_b64_tr_b16 v[146:147], v162 offset:512
    ds_read_b64_tr_b16 v[148:149], v163 offset:0
    ds_read_b64_tr_b16 v[150:151], v163 offset:512
    ds_read_b64_tr_b16 v[152:153], v162 offset:2048
    ds_read_b64_tr_b16 v[154:155], v162 offset:2560
    ds_read_b64_tr_b16 v[156:157], v163 offset:2048
    ds_read_b64_tr_b16 v[158:159], v163 offset:2560
    s_add_u32 s41, s40, 11
    s_and_b32 s41, s41, 7
    s_add_u32 s42, s46, 11
    s_and_b32 s42, s42, 8
    s_or_b32 s41, s41, s42
    s_mul_i32 s42, s41, 36864
    s_lshl_b32 s41, s41, 11
    s_add_u32 s37, s41, 0
    buffer_load_dwordx4 v[96:99], v160, s[4:7], s37 offen offset:0 sc1
    s_add_u32 s37, s41, 262144
    buffer_load_dwordx4 v[100:103], v160, s[4:7], s37 offen offset:0 sc1
    s_add_u32 s37, s41, 0
    buffer_load_dwordx4 v[104:107], v160, s[4:7], s37 offen offset:1024 sc1
    s_add_u32 s37, s41, 262144
    buffer_load_dwordx4 v[108:111], v160, s[4:7], s37 offen offset:1024 sc1
    s_add_u32 m0, s36, 8192
    s_add_u32 s37, s42, 0
    buffer_load_dwordx4 v161, s[8:11], s37 offen lds
    s_add_u32 m0, s36, 9216
    s_add_u32 s37, s42, 9216
    buffer_load_dwordx4 v161, s[8:11], s37 offen lds
    s_add_u32 m0, s36, 10240
    s_add_u32 s37, s42, 18432
    buffer_load_dwordx4 v161, s[8:11], s37 offen lds
    s_add_u32 m0, s36, 11264
    s_add_u32 s37, s42, 27648
    buffer_load_dwordx4 v161, s[8:11], s37 offen lds
    s_waitcnt lgkmcnt(6)
    v_mfma_f32_32x32x16_bf16 v[0:15], v[144:147], v[64:67], v[0:15]
    v_mfma_f32_32x32x16_bf16 v[16:31], v[144:147], v[68:71], v[16:31]
    s_waitcnt lgkmcnt(4)
    v_mfma_f32_32x32x16_bf16 v[32:47], v[148:151], v[64:67], v[32:47]
    v_mfma_f32_32x32x16_bf16 v[48:63], v[148:151], v[68:71], v[48:63]
    s_waitcnt lgkmcnt(2)
    v_mfma_f32_32x32x16_bf16 v[0:15], v[152:155], v[72:75], v[0:15]
    v_mfma_f32_32x32x16_bf16 v[16:31], v[152:155], v[76:79], v[16:31]
    s_waitcnt lgkmcnt(0)
    v_mfma_f32_32x32x16_bf16 v[32:47], v[156:159], v[72:75], v[32:47]
    v_mfma_f32_32x32x16_bf16 v[48:63], v[156:159], v[76:79], v[48:63]
    s_waitcnt vmcnt(8)
    ds_read_b64_tr_b16 v[128:129], v162 offset:4096
    ds_read_b64_tr_b16 v[130:131], v162 offset:4608
    ds_read_b64_tr_b16 v[132:133], v163 offset:4096
    ds_read_b64_tr_b16 v[134:135], v163 offset:4608
    ds_read_b64_tr_b16 v[136:137], v162 offset:6144
    ds_read_b64_tr_b16 v[138:139], v162 offset:6656
    ds_read_b64_tr_b16 v[140:141], v163 offset:6144
    ds_read_b64_tr_b16 v[142:143], v163 offset:6656
    s_add_u32 s41, s40, 12
    s_and_b32 s41, s41, 7
    s_add_u32 s42, s46, 12
    s_and_b32 s42, s42, 8
    s_or_b32 s41, s41, s42
    s_mul_i32 s42, s41, 36864
    s_lshl_b32 s41, s41, 11
    s_add_u32 s37, s41, 0
    buffer_load_dwordx4 v[64:67], v160, s[4:7], s37 offen offset:0 sc1
    s_add_u32 s37, s41, 262144
    buffer_load_dwordx4 v[68:71], v160, s[4:7], s37 offen offset:0 sc1
    s_add_u32 s37, s41, 0
    buffer_load_dwordx4 v[72:75], v160, s[4:7], s37 offen offset:1024 sc1
    s_add_u32 s37, s41, 262144
    buffer_load_dwordx4 v[76:79], v160, s[4:7], s37 offen offset:1024 sc1
    s_waitcnt lgkmcnt(6)
    v_mfma_f32_32x32x16_bf16 v[0:15], v[128:131], v[80:83], v[0:15]
    v_mfma_f32_32x32x16_bf16 v[16:31], v[128:131], v[84:87], v[16:31]
    s_waitcnt lgkmcnt(4)
    v_mfma_f32_32x32x16_bf16 v[32:47], v[132:135], v[80:83], v[32:47]
    v_mfma_f32_32x32x16_bf16 v[48:63], v[132:135], v[84:87], v[48:63]
    s_waitcnt lgkmcnt(2)
    v_mfma_f32_32x32x16_bf16 v[0:15], v[136:139], v[88:91], v[0:15]
    v_mfma_f32_32x32x16_bf16 v[16:31], v[136:139], v[92:95], v[16:31]
    s_waitcnt lgkmcnt(0)
    v_mfma_f32_32x32x16_bf16 v[32:47], v[140:143], v[88:91], v[32:47]
    v_mfma_f32_32x32x16_bf16 v[48:63], v[140:143], v[92:95], v[48:63]
    s_waitcnt vmcnt(4)
    ds_read_b64_tr_b16 v[144:145], v162 offset:8192
    ds_read_b64_tr_b16 v[146:147], v162 offset:8704
    ds_read_b64_tr_b16 v[148:149], v163 offset:8192
    ds_read_b64_tr_b16 v[150:151], v163 offset:8704
    ds_read_b64_tr_b16 v[152:153], v162 offset:10240
    ds_read_b64_tr_b16 v[154:155], v162 offset:10752
    ds_read_b64_tr_b16 v[156:157], v163 offset:10240
    ds_read_b64_tr_b16 v[158:159], v163 offset:10752
    s_add_u32 s41, s40, 13
    s_and_b32 s41, s41, 7
    s_add_u32 s42, s46, 13
    s_and_b32 s42, s42, 8
    s_or_b32 s41, s41, s42
    s_mul_i32 s42, s41, 36864
    s_lshl_b32 s41, s41, 11
    s_add_u32 s37, s41, 0
    buffer_load_dwordx4 v[80:83], v160, s[4:7], s37 offen offset:0 sc1
    s_add_u32 s37, s41, 262144
    buffer_load_dwordx4 v[84:87], v160, s[4:7], s37 offen offset:0 sc1
    s_add_u32 s37, s41, 0
    buffer_load_dwordx4 v[88:91], v160, s[4:7], s37 offen offset:1024 sc1
    s_add_u32 s37, s41, 262144
    buffer_load_dwordx4 v[92:95], v160, s[4:7], s37 offen offset:1024 sc1
    s_waitcnt lgkmcnt(6)
    v_mfma_f32_32x32x16_bf16 v[0:15], v[144:147], v[96:99], v[0:15]
    v_mfma_f32_32x32x16_bf16 v[16:31], v[144:147], v[100:103], v[16:31]
    s_waitcnt lgkmcnt(4)
    v_mfma_f32_32x32x16_bf16 v[32:47], v[148:151], v[96:99], v[32:47]
    v_mfma_f32_32x32x16_bf16 v[48:63], v[148:151], v[100:103], v[48:63]
    s_waitcnt lgkmcnt(2)
    v_mfma_f32_32x32x16_bf16 v[0:15], v[152:155], v[104:107], v[0:15]
    v_mfma_f32_32x32x16_bf16 v[16:31], v[152:155], v[108:111], v[16:31]
    s_waitcnt lgkmcnt(0)
    v_mfma_f32_32x32x16_bf16 v[32:47], v[156:159], v[104:107], v[32:47]
    v_mfma_f32_32x32x16_bf16 v[48:63], v[156:159], v[108:111], v[48:63]
    s_waitcnt vmcnt(4)
    s_add_u32 s41, s40, 14
    s_and_b32 s41, s41, 7
    s_add_u32 s42, s46, 14
    s_and_b32 s42, s42, 8
    s_or_b32 s41, s41, s42
    s_mul_i32 s42, s41, 36864
    s_lshl_b32 s41, s41, 11
    s_add_u32 s37, s41, 0
    buffer_load_dwordx4 v[96:99], v160, s[4:7], s37 offen offset:0 sc1
    s_add_u32 s37, s41, 262144
    buffer_load_dwordx4 v[100:103], v160, s[4:7], s37 offen offset:0 sc1
    s_add_u32 s37, s41, 0
    buffer_load_dwordx4 v[104:107], v160, s[4:7], s37 offen offset:1024 sc1
    s_add_u32 s37, s41, 262144
    buffer_load_dwordx4 v[108:111], v160, s[4:7], s37 offen offset:1024 sc1
    s_waitcnt lgkmcnt(6)
    v_mfma_f32_32x32x16_bf16 v[0:15], v[168:171], v[64:67], v[0:15]
    v_mfma_f32_32x32x16_bf16 v[16:31], v[168:171], v[68:71], v[16:31]
    s_waitcnt lgkmcnt(4)
    v_mfma_f32_32x32x16_bf16 v[32:47], v[172:175], v[64:67], v[32:47]
    v_mfma_f32_32x32x16_bf16 v[48:63], v[172:175], v[68:71], v[48:63]
    s_waitcnt lgkmcnt(2)
    v_mfma_f32_32x32x16_bf16 v[0:15], v[176:179], v[72:75], v[0:15]
    v_mfma_f32_32x32x16_bf16 v[16:31], v[176:179], v[76:79], v[16:31]
    s_waitcnt lgkmcnt(0)
    v_mfma_f32_32x32x16_bf16 v[32:47], v[180:183], v[72:75], v[32:47]
    v_mfma_f32_32x32x16_bf16 v[48:63], v[180:183], v[76:79], v[48:63]
    s_waitcnt vmcnt(4)
    s_add_u32 s41, s40, 15
    s_and_b32 s41, s41, 7
    s_add_u32 s42, s46, 15
    s_and_b32 s42, s42, 8
    s_or_b32 s41, s41, s42
    s_mul_i32 s42, s41, 36864
    s_lshl_b32 s41, s41, 11
    s_add_u32 s37, s41, 0
    buffer_load_dwordx4 v[64:67], v160, s[4:7], s37 offen offset:0 sc1
    s_add_u32 s37, s41, 262144
    buffer_load_dwordx4 v[68:71], v160, s[4:7], s37 offen offset:0 sc1
    s_add_u32 s37, s41, 0
    buffer_load_dwordx4 v[72:75], v160, s[4:7], s37 offen offset:1024 sc1
    s_add_u32 s37, s41, 262144
    buffer_load_dwordx4 v[76:79], v160, s[4:7], s37 offen offset:1024 sc1
    s_waitcnt lgkmcnt(6)
    v_mfma_f32_32x32x16_bf16 v[0:15], v[184:187], v[80:83], v[0:15]
    v_mfma_f32_32x32x16_bf16 v[16:31], v[184:187], v[84:87], v[16:31]
    s_waitcnt lgkmcnt(4)
    v_mfma_f32_32x32x16_bf16 v[32:47], v[188:191], v[80:83], v[32:47]
    v_mfma_f32_32x32x16_bf16 v[48:63], v[188:191], v[84:87], v[48:63]
    s_waitcnt lgkmcnt(2)
    v_mfma_f32_32x32x16_bf16 v[0:15], v[192:195], v[88:91], v[0:15]
    v_mfma_f32_32x32x16_bf16 v[16:31], v[192:195], v[92:95], v[16:31]
    s_waitcnt lgkmcnt(0)
    v_mfma_f32_32x32x16_bf16 v[32:47], v[196:199], v[88:91], v[32:47]
    v_mfma_f32_32x32x16_bf16 v[48:63], v[196:199], v[92:95], v[48:63]
    s_waitcnt vmcnt(4)
    s_waitcnt lgkmcnt(6)
    v_mfma_f32_32x32x16_bf16 v[0:15], v[200:203], v[96:99], v[0:15]
    v_mfma_f32_32x32x16_bf16 v[16:31], v[200:203], v[100:103], v[16:31]
    s_waitcnt lgkmcnt(4)
    v_mfma_f32_32x32x16_bf16 v[32:47], v[204:207], v[96:99], v[32:47]
    v_mfma_f32_32x32x16_bf16 v[48:63], v[204:207], v[100:103], v[48:63]
    s_waitcnt lgkmcnt(2)
    v_mfma_f32_32x32x16_bf16 v[0:15], v[208:211], v[104:107], v[0:15]
    v_mfma_f32_32x32x16_bf16 v[16:31], v[208:211], v[108:111], v[16:31]
    s_waitcnt lgkmcnt(0)
    v_mfma_f32_32x32x16_bf16 v[32:47], v[212:215], v[104:107], v[32:47]
    v_mfma_f32_32x32x16_bf16 v[48:63], v[212:215], v[108:111], v[48:63]
    s_waitcnt vmcnt(0)
    s_waitcnt lgkmcnt(6)
    v_mfma_f32_32x32x16_bf16 v[0:15], v[216:219], v[64:67], v[0:15]
    v_mfma_f32_32x32x16_bf16 v[16:31], v[216:219], v[68:71], v[16:31]
    s_waitcnt lgkmcnt(4)
    v_mfma_f32_32x32x16_bf16 v[32:47], v[220:223], v[64:67], v[32:47]
    v_mfma_f32_32x32x16_bf16 v[48:63], v[220:223], v[68:71], v[48:63]
    s_waitcnt lgkmcnt(2)
    v_mfma_f32_32x32x16_bf16 v[0:15], v[224:227], v[72:75], v[0:15]
    v_mfma_f32_32x32x16_bf16 v[16:31], v[224:227], v[76:79], v[16:31]
    s_waitcnt lgkmcnt(0)
    v_mfma_f32_32x32x16_bf16 v[32:47], v[228:231], v[72:75], v[32:47]
    v_mfma_f32_32x32x16_bf16 v[48:63], v[228:231], v[76:79], v[48:63]
    s_add_u32 s4, s4, 131072
    s_addc_u32 s5, s5, 0
    s_add_u32 s8, s8, 2359296
    s_addc_u32 s9, s9, 0
    s_add_u32 s41, s40, 12
    s_and_b32 s41, s41, 7
    s_add_u32 s42, s46, 12
    s_and_b32 s42, s42, 8
    s_or_b32 s41, s41, s42
    s_mul_i32 s42, s41, 36864
    s_lshl_b32 s41, s41, 11
    s_add_u32 m0, s36, 0
    s_add_u32 s37, s42, 0
    buffer_load_dwordx4 v161, s[8:11], s37 offen lds
    s_add_u32 m0, s36, 1024
    s_add_u32 s37, s42, 9216
    buffer_load_dwordx4 v161, s[8:11], s37 offen lds
    s_add_u32 m0, s36, 2048
    s_add_u32 s37, s42, 18432
    buffer_load_dwordx4 v161, s[8:11], s37 offen lds
    s_add_u32 m0, s36, 3072
    s_add_u32 s37, s42, 27648
    buffer_load_dwordx4 v161, s[8:11], s37 offen lds
    s_add_u32 s41, s40, 13
    s_and_b32 s41, s41, 7
    s_add_u32 s42, s46, 13
    s_and_b32 s42, s42, 8
    s_or_b32 s41, s41, s42
    s_mul_i32 s42, s41, 36864
    s_lshl_b32 s41, s41, 11
    s_add_u32 m0, s36, 4096
    s_add_u32 s37, s42, 0
    buffer_load_dwordx4 v161, s[8:11], s37 offen lds
    s_add_u32 m0, s36, 5120
    s_add_u32 s37, s42, 9216
    buffer_load_dwordx4 v161, s[8:11], s37 offen lds
    s_add_u32 m0, s36, 6144
    s_add_u32 s37, s42, 18432
    buffer_load_dwordx4 v161, s[8:11], s37 offen lds
    s_add_u32 m0, s36, 7168
    s_add_u32 s37, s42, 27648
    buffer_load_dwordx4 v161, s[8:11], s37 offen lds
    s_add_u32 s41, s40, 14
    s_and_b32 s41, s41, 7
    s_add_u32 s42, s46, 14
    s_and_b32 s42, s42, 8
    s_or_b32 s41, s41, s42
    s_mul_i32 s42, s41, 36864
    s_lshl_b32 s41, s41, 11
    s_add_u32 m0, s36, 8192
    s_add_u32 s37, s42, 0
    buffer_load_dwordx4 v161, s[8:11], s37 offen lds
    s_add_u32 m0, s36, 9216
    s_add_u32 s37, s42, 9216
    buffer_load_dwordx4 v161, s[8:11], s37 offen lds
    s_add_u32 m0, s36, 10240
    s_add_u32 s37, s42, 18432
    buffer_load_dwordx4 v161, s[8:11], s37 offen lds
    s_add_u32 m0, s36, 11264
    s_add_u32 s37, s42, 27648
    buffer_load_dwordx4 v161, s[8:11], s37 offen lds
    s_add_u32 s41, s40, 15
    s_and_b32 s41, s41, 7
    s_add_u32 s42, s46, 15
    s_and_b32 s42, s42, 8
    s_or_b32 s41, s41, s42
    s_mul_i32 s42, s41, 36864
    s_lshl_b32 s41, s41, 11
    s_add_u32 m0, s36, 12288
    s_add_u32 s37, s42, 0
    buffer_load_dwordx4 v161, s[8:11], s37 offen lds
    s_add_u32 m0, s36, 13312
    s_add_u32 s37, s42, 9216
    buffer_load_dwordx4 v161, s[8:11], s37 offen lds
    s_add_u32 m0, s36, 14336
    s_add_u32 s37, s42, 18432
    buffer_load_dwordx4 v161, s[8:11], s37 offen lds
    s_add_u32 m0, s36, 15360
    s_add_u32 s37, s42, 27648
    buffer_load_dwordx4 v161, s[8:11], s37 offen lds
    s_waitcnt vmcnt(12) lgkmcnt(0)
    ds_read_b64_tr_b16 v[168:169], v162 offset:0
    ds_read_b64_tr_b16 v[170:171], v162 offset:512
    ds_read_b64_tr_b16 v[172:173], v163 offset:0
    ds_read_b64_tr_b16 v[174:175], v163 offset:512
    ds_read_b64_tr_b16 v[176:177], v162 offset:2048
    ds_read_b64_tr_b16 v[178:179], v162 offset:2560
    ds_read_b64_tr_b16 v[180:181], v163 offset:2048
    ds_read_b64_tr_b16 v[182:183], v163 offset:2560
    s_waitcnt vmcnt(8) lgkmcnt(0)
    ds_read_b64_tr_b16 v[184:185], v162 offset:4096
    ds_read_b64_tr_b16 v[186:187], v162 offset:4608
    ds_read_b64_tr_b16 v[188:189], v163 offset:4096
    ds_read_b64_tr_b16 v[190:191], v163 offset:4608
    ds_read_b64_tr_b16 v[192:193], v162 offset:6144
    ds_read_b64_tr_b16 v[194:195], v162 offset:6656
    ds_read_b64_tr_b16 v[196:197], v163 offset:6144
    ds_read_b64_tr_b16 v[198:199], v163 offset:6656
    s_waitcnt vmcnt(4) lgkmcnt(0)
    ds_read_b64_tr_b16 v[200:201], v162 offset:8192
    ds_read_b64_tr_b16 v[202:203], v162 offset:8704
    ds_read_b64_tr_b16 v[204:205], v163 offset:8192
    ds_read_b64_tr_b16 v[206:207], v163 offset:8704
    ds_read_b64_tr_b16 v[208:209], v162 offset:10240
    ds_read_b64_tr_b16 v[210:211], v162 offset:10752
    ds_read_b64_tr_b16 v[212:213], v163 offset:10240
    ds_read_b64_tr_b16 v[214:215], v163 offset:10752
    s_waitcnt vmcnt(0) lgkmcnt(0)
    ds_read_b64_tr_b16 v[216:217], v162 offset:12288
    ds_read_b64_tr_b16 v[218:219], v162 offset:12800
    ds_read_b64_tr_b16 v[220:221], v163 offset:12288
    ds_read_b64_tr_b16 v[222:223], v163 offset:12800
    ds_read_b64_tr_b16 v[224:225], v162 offset:14336
    ds_read_b64_tr_b16 v[226:227], v162 offset:14848
    ds_read_b64_tr_b16 v[228:229], v163 offset:14336
    ds_read_b64_tr_b16 v[230:231], v163 offset:14848
    s_waitcnt lgkmcnt(0)
    s_add_u32 s41, s40, 0
    s_and_b32 s41, s41, 7
    s_add_u32 s42, s46, 0
    s_and_b32 s42, s42, 8
    s_or_b32 s41, s41, s42
    s_mul_i32 s42, s41, 36864
    s_lshl_b32 s41, s41, 11
    s_add_u32 m0, s36, 0
    s_add_u32 s37, s42, 0
    buffer_load_dwordx4 v161, s[8:11], s37 offen lds
    s_add_u32 m0, s36, 1024
    s_add_u32 s37, s42, 9216
    buffer_load_dwordx4 v161, s[8:11], s37 offen lds
    s_add_u32 m0, s36, 2048
    s_add_u32 s37, s42, 18432
    buffer_load_dwordx4 v161, s[8:11], s37 offen lds
    s_add_u32 m0, s36, 3072
    s_add_u32 s37, s42, 27648
    buffer_load_dwordx4 v161, s[8:11], s37 offen lds
    s_add_u32 s41, s40, 1
    s_and_b32 s41, s41, 7
    s_add_u32 s42, s46, 1
    s_and_b32 s42, s42, 8
    s_or_b32 s41, s41, s42
    s_mul_i32 s42, s41, 36864
    s_lshl_b32 s41, s41, 11
    s_add_u32 m0, s36, 4096
    s_add_u32 s37, s42, 0
    buffer_load_dwordx4 v161, s[8:11], s37 offen lds
    s_add_u32 m0, s36, 5120
    s_add_u32 s37, s42, 9216
    buffer_load_dwordx4 v161, s[8:11], s37 offen lds
    s_add_u32 m0, s36, 6144
    s_add_u32 s37, s42, 18432
    buffer_load_dwordx4 v161, s[8:11], s37 offen lds
    s_add_u32 m0, s36, 7168
    s_add_u32 s37, s42, 27648
    buffer_load_dwordx4 v161, s[8:11], s37 offen lds
    s_cmp_lg_u32 s32, 0
    s_cbranch_scc1 K2_GO1
K2_POLL1:
    global_load_dword v164, v166, s[56:57] offset:2048 sc1
    s_waitcnt vmcnt(0)
    v_cmp_eq_u32 vcc, 0, v164
    s_cbranch_vccz K2_GO1
    s_sleep 8
    s_branch K2_POLL1
K2_GO1:
    s_barrier
    s_add_u32 s41, s40, 0
    s_and_b32 s41, s41, 7
    s_add_u32 s42, s46, 0
    s_and_b32 s42, s42, 8
    s_or_b32 s41, s41, s42
    s_mul_i32 s42, s41, 36864
    s_lshl_b32 s41, s41, 11
    s_add_u32 s37, s41, 0
    buffer_load_dwordx4 v[64:67], v160, s[4:7], s37 offen offset:0 sc1
    s_add_u32 s37, s41, 262144
    buffer_load_dwordx4 v[68:71], v160, s[4:7], s37 offen offset:0 sc1
    s_add_u32 s37, s41, 0
    buffer_load_dwordx4 v[72:75], v160, s[4:7], s37 offen offset:1024 sc1
    s_add_u32 s37, s41, 262144
    buffer_load_dwordx4 v[76:79], v160, s[4:7], s37 offen offset:1024 sc1
    s_add_u32 s41, s40, 1
    s_and_b32 s41, s41, 7
    s_add_u32 s42, s46, 1
    s_and_b32 s42, s42, 8
    s_or_b32 s41, s41, s42
    s_mul_i32 s42, s41, 36864
    s_lshl_b32 s41, s41, 11
    s_add_u32 s37, s41, 0
    buffer_load_dwordx4 v[80:83], v160, s[4:7], s37 offen offset:0 sc1
    s_add_u32 s37, s41, 262144
    buffer_load_dwordx4 v[84:87], v160, s[4:7], s37 offen offset:0 sc1
    s_add_u32 s37, s41, 0
    buffer_load_dwordx4 v[88:91], v160, s[4:7], s37 offen offset:1024 sc1
    s_add_u32 s37, s41, 262144
    buffer_load_dwordx4 v[92:95], v160, s[4:7], s37 offen offset:1024 sc1
    s_waitcnt vmcnt(4)
    ds_read_b64_tr_b16 v[128:129], v162 offset:0
    ds_read_b64_tr_b16 v[130:131], v162 offset:512
    ds_read_b64_tr_b16 v[132:133], v163 offset:0
    ds_read_b64_tr_b16 v[134:135], v163 offset:512
    ds_read_b64_tr_b16 v[136:137], v162 offset:2048
    ds_read_b64_tr_b16 v[138:139], v162 offset:2560
    ds_read_b64_tr_b16 v[140:141], v163 offset:2048
    ds_read_b64_tr_b16 v[142:143], v163 offset:2560
    s_add_u32 s41, s40, 2
    s_and_b32 s41, s41, 7
    s_add_u32 s42, s46, 2
    s_and_b32 s42, s42, 8
    s_or_b32 s41, s41, s42
    s_mul_i32 s42, s41, 36864
    s_lshl_b32 s41, s41, 11
    s_add_u32 s37, s41, 0
    buffer_load_dwordx4 v[96:99], v160, s[4:7], s37 offen offset:0 sc1
    s_add_u32 s37, s41, 262144
    buffer_load_dwordx4 v[100:103], v160, s[4:7], s37 offen offset:0 sc1
    s_add_u32 s37, s41, 0
    buffer_load_dwordx4 v[104:107], v160, s[4:7], s37 offen offset:1024 sc1
    s_add_u32 s37, s41, 262144
    buffer_load_dwordx4 v[108:111], v160, s[4:7], s37 offen offset:1024 sc1
    s_add_u32 m0, s36, 8192
    s_add_u32 s37, s42, 0
    buffer_load_dwordx4 v161, s[8:11], s37 offen lds
    s_add_u32 m0, s36, 9216
    s_add_u32 s37, s42, 9216
    buffer_load_dwordx4 v161, s[8:11], s37 offen lds
    s_add_u32 m0, s36, 10240
    s_add_u32 s37, s42, 18432
    buffer_load_dwordx4 v161, s[8:11], s37 offen lds
    s_add_u32 m0, s36, 11264
    s_add_u32 s37, s42, 27648
    buffer_load_dwordx4 v161, s[8:11], s37 offen lds
    s_waitcnt lgkmcnt(6)
    v_mfma_f32_32x32x16_bf16 v[0:15], v[128:131], v[64:67], v[0:15]
    v_mfma_f32_32x32x16_bf16 v[16:31], v[128:131], v[68:71], v[16:31]
    s_waitcnt lgkmcnt(4)
    v_mfma_f32_32x32x16_bf16 v[32:47], v[132:135], v[64:67], v[32:47]
    v_mfma_f32_32x32x16_bf16 v[48:63], v[132:135], v[68:71], v[48:63]
    s_waitcnt lgkmcnt(2)
    v_mfma_f32_32x32x16_bf16 v[0:15], v[136:139], v[72:75], v[0:15]
    v_mfma_f32_32x32x16_bf16 v[16:31], v[136:139], v[76:79], v[16:31]
    s_waitcnt lgkmcnt(0)
    v_mfma_f32_32x32x16_bf16 v[32:47], v[140:143], v[72:75], v[32:47]
    v_mfma_f32_32x32x16_bf16 v[48:63], v[140:143], v[76:79], v[48:63]
    s_waitcnt vmcnt(8)
    ds_read_b64_tr_b16 v[144:145], v162 offset:4096
    ds_read_b64_tr_b16 v[146:147], v162 offset:4608
    ds_read_b64_tr_b16 v[148:149], v163 offset:4096
    ds_read_b64_tr_b16 v[150:151], v163 offset:4608
    ds_read_b64_tr_b16 v[152:153], v162 offset:6144
    ds_read_b64_tr_b16 v[154:155], v162 offset:6656
    ds_read_b64_tr_b16 v[156:157], v163 offset:6144
    ds_read_b64_tr_b16 v[158:159], v163 offset:6656
    s_add_u32 s41, s40, 3
    s_and_b32 s41, s41, 7
    s_add_u32 s42, s46, 3
    s_and_b32 s42, s42, 8
    s_or_b32 s41, s41, s42
    s_mul_i32 s42, s41, 36864
    s_lshl_b32 s41, s41, 11
    s_add_u32 s37, s41, 0
    buffer_load_dwordx4 v[64:67], v160, s[4:7], s37 offen offset:0 sc1
    s_add_u32 s37, s41, 262144
    buffer_load_dwordx4 v[68:71], v160, s[4:7], s37 offen offset:0 sc1
    s_add_u32 s37, s41, 0
    buffer_load_dwordx4 v[72:75], v160, s[4:7], s37 offen offset:1024 sc1
    s_add_u32 s37, s41, 262144
    buffer_load_dwordx4 v[76:79], v160, s[4:7], s37 offen offset:1024 sc1
    s_add_u32 m0, s36, 0
    s_add_u32 s37, s42, 0
    buffer_load_dwordx4 v161, s[8:11], s37 offen lds
    s_add_u32 m0, s36, 1024
    s_add_u32 s37, s42, 9216
    buffer_load_dwordx4 v161, s[8:11], s37 offen lds
    s_add_u32 m0, s36, 2048
    s_add_u32 s37, s42, 18432
    buffer_load_dwordx4 v161, s[8:11], s37 offen lds
    s_add_u32 m0, s36, 3072
    s_add_u32 s37, s42, 27648
    buffer_load_dwordx4 v161, s[8:11], s37 offen lds
    s_waitcnt lgkmcnt(6)
    v_mfma_f32_32x32x16_bf16 v[0:15], v[144:147], v[80:83], v[0:15]
    v_mfma_f32_32x32x16_bf16 v[16:31], v[144:147], v[84:87], v[16:31]
    s_waitcnt lgkmcnt(4)
    v_mfma_f32_32x32x16_bf16 v[32:47], v[148:151], v[80:83], v[32:47]
    v_mfma_f32_32x32x16_bf16 v[48:63], v[148:151], v[84:87], v[48:63]
    s_waitcnt lgkmcnt(2)
    v_mfma_f32_32x32x16_bf16 v[0:15], v[152:155], v[88:91], v[0:15]
    v_mfma_f32_32x32x16_bf16 v[16:31], v[152:155], v[92:95], v[16:31]
    s_waitcnt lgkmcnt(0)
    v_mfma_f32_32x32x16_bf16 v[32:47], v[156:159], v[88:91], v[32:47]
    v_mfma_f32_32x32x16_bf16 v[48:63], v[156:159], v[92:95], v[48:63]
    s_waitcnt vmcnt(8)
    ds_read_b64_tr_b16 v[128:129], v162 offset:8192
    ds_read_b64_tr_b16 v[130:131], v162 offset:8704
    ds_read_b64_tr_b16 v[132:133], v163 offset:8192
    ds_read_b64_tr_b16 v[134:135], v163 offset:8704
    ds_read_b64_tr_b16 v[136:137], v162 offset:10240
    ds_read_b64_tr_b16 v[138:139], v162 offset:10752
    ds_read_b64_tr_b16 v[140:141], v163 offset:10240
    ds_read_b64_tr_b16 v[142:143], v163 offset:10752
    s_add_u32 s41, s40, 4
    s_and_b32 s41, s41, 7
    s_add_u32 s42, s46, 4
    s_and_b32 s42, s42, 8
    s_or_b32 s41, s41, s42
    s_mul_i32 s42, s41, 36864
    s_lshl_b32 s41, s41, 11
    s_add_u32 s37, s41, 0
    buffer_load_dwordx4 v[80:83], v160, s[4:7], s37 offen offset:0 sc1
    s_add_u32 s37, s41, 262144
    buffer_load_dwordx4 v[84:87], v160, s[4:7], s37 offen offset:0 sc1
    s_add_u32 s37, s41, 0
    buffer_load_dwordx4 v[88:91], v160, s[4:7], s37 offen offset:1024 sc1
    s_add_u32 s37, s41, 262144
    buffer_load_dwordx4 v[92:95], v160, s[4:7], s37 offen offset:1024 sc1
    s_add_u32 m0, s36, 4096
    s_add_u32 s37, s42, 0
    buffer_load_dwordx4 v161, s[8:11], s37 offen lds
    s_add_u32 m0, s36, 5120
    s_add_u32 s37, s42, 9216
    buffer_load_dwordx4 v161, s[8:11], s37 offen lds
    s_add_u32 m0, s36, 6144
    s_add_u32 s37, s42, 18432
    buffer_load_dwordx4 v161, s[8:11], s37 offen lds
    s_add_u32 m0, s36, 7168
    s_add_u32 s37, s42, 27648
    buffer_load_dwordx4 v161, s[8:11], s37 offen lds
    s_waitcnt lgkmcnt(6)
    v_mfma_f32_32x32x16_bf16 v[0:15], v[128:131], v[96:99], v[0:15]
    v_mfma_f32_32x32x16_bf16 v[16:31], v[128:131], v[100:103], v[16:31]
    s_waitcnt lgkmcnt(4)
    v_mfma_f32_32x32x16_bf16 v[32:47], v[132:135], v[96:99], v[32:47]
    v_mfma_f32_32x32x16_bf16 v[48:63], v[132:135], v[100:103], v[48:63]
    s_waitcnt lgkmcnt(2)
    v_mfma_f32_32x32x16_bf16 v[0:15], v[136:139], v[104:107], v[0:15]
    v_mfma_f32_32x32x16_bf16 v[16:31], v[136:139], v[108:111], v[16:31]
    s_waitcnt lgkmcnt(0)
    v_mfma_f32_32x32x16_bf16 v[32:47], v[140:143], v[104:107], v[32:47]
    v_mfma_f32_32x32x16_bf16 v[48:63], v[140:143], v[108:111], v[48:63]
    s_waitcnt vmcnt(8)
    ds_read_b64_tr_b16 v[144:145], v162 offset:0
    ds_read_b64_tr_b16 v[146:147], v162 offset:512
    ds_read_b64_tr_b16 v[148:149], v163 offset:0
    ds_read_b64_tr_b16 v[150:151], v163 offset:512
    ds_read_b64_tr_b16 v[152:153], v162 offset:2048
    ds_read_b64_tr_b16 v[154:155], v162 offset:2560
    ds_read_b64_tr_b16 v[156:157], v163 offset:2048
    ds_read_b64_tr_b16 v[158:159], v163 offset:2560
    s_add_u32 s41, s40, 5
    s_and_b32 s41, s41, 7
    s_add_u32 s42, s46, 5
    s_and_b32 s42, s42, 8
    s_or_b32 s41, s41, s42
    s_mul_i32 s42, s41, 36864
    s_lshl_b32 s41, s41, 11
    s_add_u32 s37, s41, 0
    buffer_load_dwordx4 v[96:99], v160, s[4:7], s37 offen offset:0 sc1
    s_add_u32 s37, s41, 262144
    buffer_load_dwordx4 v[100:103], v160, s[4:7], s37 offen offset:0 sc1
    s_add_u32 s37, s41, 0
    buffer_load_dwordx4 v[104:107], v160, s[4:7], s37 offen offset:1024 sc1
    s_add_u32 s37, s41, 262144
    buffer_load_dwordx4 v[108:111], v160, s[4:7], s37 offen offset:1024 sc1
    s_add_u32 m0, s36, 8192
    s_add_u32 s37, s42, 0
    buffer_load_dwordx4 v161, s[8:11], s37 offen lds
    s_add_u32 m0, s36, 9216
    s_add_u32 s37, s42, 9216
    buffer_load_dwordx4 v161, s[8:11], s37 offen lds
    s_add_u32 m0, s36, 10240
    s_add_u32 s37, s42, 18432
    buffer_load_dwordx4 v161, s[8:11], s37 offen lds
    s_add_u32 m0, s36, 11264
    s_add_u32 s37, s42, 27648
    buffer_load_dwordx4 v161, s[8:11], s37 offen lds
    s_waitcnt lgkmcnt(6)
    v_mfma_f32_32x32x16_bf16 v[0:15], v[144:147], v[64:67], v[0:15]
    v_mfma_f32_32x32x16_bf16 v[16:31], v[144:147], v[68:71], v[16:31]
    s_waitcnt lgkmcnt(4)
    v_mfma_f32_32x32x16_bf16 v[32:47], v[148:151], v[64:67], v[32:47]
    v_mfma_f32_32x32x16_bf16 v[48:63], v[148:151], v[68:71], v[48:63]
    s_waitcnt lgkmcnt(2)
    v_mfma_f32_32x32x16_bf16 v[0:15], v[152:155], v[72:75], v[0:15]
    v_mfma_f32_32x32x16_bf16 v[16:31], v[152:155], v[76:79], v[16:31]
    s_waitcnt lgkmcnt(0)
    v_mfma_f32_32x32x16_bf16 v[32:47], v[156:159], v[72:75], v[32:47]
    v_mfma_f32_32x32x16_bf16 v[48:63], v[156:159], v[76:79], v[48:63]
    s_waitcnt vmcnt(8)
    ds_read_b64_tr_b16 v[128:129], v162 offset:4096
    ds_read_b64_tr_b16 v[130:131], v162 offset:4608
    ds_read_b64_tr_b16 v[132:133], v163 offset:4096
    ds_read_b64_tr_b16 v[134:135], v163 offset:4608
    ds_read_b64_tr_b16 v[136:137], v162 offset:6144
    ds_read_b64_tr_b16 v[138:139], v162 offset:6656
    ds_read_b64_tr_b16 v[140:141], v163 offset:6144
    ds_read_b64_tr_b16 v[142:143], v163 offset:6656
    s_add_u32 s41, s40, 6
    s_and_b32 s41, s41, 7
    s_add_u32 s42, s46, 6
    s_and_b32 s42, s42, 8
    s_or_b32 s41, s41, s42
    s_mul_i32 s42, s41, 36864
    s_lshl_b32 s41, s41, 11
    s_add_u32 s37, s41, 0
    buffer_load_dwordx4 v[64:67], v160, s[4:7], s37 offen offset:0 sc1
    s_add_u32 s37, s41, 262144
    buffer_load_dwordx4 v[68:71], v160, s[4:7], s37 offen offset:0 sc1
    s_add_u32 s37, s41, 0
    buffer_load_dwordx4 v[72:75], v160, s[4:7], s37 offen offset:1024 sc1
    s_add_u32 s37, s41, 262144
    buffer_load_dwordx4 v[76:79], v160, s[4:7], s37 offen offset:1024 sc1
    s_add_u32 m0, s36, 0
    s_add_u32 s37, s42, 0
    buffer_load_dwordx4 v161, s[8:11], s37 offen lds
    s_add_u32 m0, s36, 1024
    s_add_u32 s37, s42, 9216
    buffer_load_dwordx4 v161, s[8:11], s37 offen lds
    s_add_u32 m0, s36, 2048
    s_add_u32 s37, s42, 18432
    buffer_load_dwordx4 v161, s[8:11], s37 offen lds
    s_add_u32 m0, s36, 3072
    s_add_u32 s37, s42, 27648
    buffer_load_dwordx4 v161, s[8:11], s37 offen lds
    s_waitcnt lgkmcnt(6)
    v_mfma_f32_32x32x16_bf16 v[0:15], v[128:131], v[80:83], v[0:15]
    v_mfma_f32_32x32x16_bf16 v[16:31], v[128:131], v[84:87], v[16:31]
    s_waitcnt lgkmcnt(4)
    v_mfma_f32_32x32x16_bf16 v[32:47], v[132:135], v[80:83], v[32:47]
    v_mfma_f32_32x32x16_bf16 v[48:63], v[132:135], v[84:87], v[48:63]
    s_waitcnt lgkmcnt(2)
    v_mfma_f32_32x32x16_bf16 v[0:15], v[136:139], v[88:91], v[0:15]
    v_mfma_f32_32x32x16_bf16 v[16:31], v[136:139], v[92:95], v[16:31]
    s_waitcnt lgkmcnt(0)
    v_mfma_f32_32x32x16_bf16 v[32:47], v[140:143], v[88:91], v[32:47]
    v_mfma_f32_32x32x16_bf16 v[48:63], v[140:143], v[92:95], v[48:63]
    s_waitcnt vmcnt(8)
    ds_read_b64_tr_b16 v[144:145], v162 offset:8192
    ds_read_b64_tr_b16 v[146:147], v162 offset:8704
    ds_read_b64_tr_b16 v[148:149], v163 offset:8192
    ds_read_b64_tr_b16 v[150:151], v163 offset:8704
    ds_read_b64_tr_b16 v[152:153], v162 offset:10240
    ds_read_b64_tr_b16 v[154:155], v162 offset:10752
    ds_read_b64_tr_b16 v[156:157], v163 offset:10240
    ds_read_b64_tr_b16 v[158:159], v163 offset:10752
    s_add_u32 s41, s40, 7
    s_and_b32 s41, s41, 7
    s_add_u32 s42, s46, 7
    s_and_b32 s42, s42, 8
    s_or_b32 s41, s41, s42
    s_mul_i32 s42, s41, 36864
    s_lshl_b32 s41, s41, 11
    s_add_u32 s37, s41, 0
    buffer_load_dwordx4 v[80:83], v160, s[4:7], s37 offen offset:0 sc1
    s_add_u32 s37, s41, 262144
    buffer_load_dwordx4 v[84:87], v160, s[4:7], s37 offen offset:0 sc1
    s_add_u32 s37, s41, 0
    buffer_load_dwordx4 v[88:91], v160, s[4:7], s37 offen offset:1024 sc1
    s_add_u32 s37, s41, 262144
    buffer_load_dwordx4 v[92:95], v160, s[4:7], s37 offen offset:1024 sc1
    s_add_u32 m0, s36, 4096
    s_add_u32 s37, s42, 0
    buffer_load_dwordx4 v161, s[8:11], s37 offen lds
    s_add_u32 m0, s36, 5120
    s_add_u32 s37, s42, 9216
    buffer_load_dwordx4 v161, s[8:11], s37 offen lds
    s_add_u32 m0, s36, 6144
    s_add_u32 s37, s42, 18432
    buffer_load_dwordx4 v161, s[8:11], s37 offen lds
    s_add_u32 m0, s36, 7168
    s_add_u32 s37, s42, 27648
    buffer_load_dwordx4 v161, s[8:11], s37 offen lds
    s_waitcnt lgkmcnt(6)
    v_mfma_f32_32x32x16_bf16 v[0:15], v[144:147], v[96:99], v[0:15]
    v_mfma_f32_32x32x16_bf16 v[16:31], v[144:147], v[100:103], v[16:31]
    s_waitcnt lgkmcnt(4)
    v_mfma_f32_32x32x16_bf16 v[32:47], v[148:151], v[96:99], v[32:47]
    v_mfma_f32_32x32x16_bf16 v[48:63], v[148:151], v[100:103], v[48:63]
    s_waitcnt lgkmcnt(2)
    v_mfma_f32_32x32x16_bf16 v[0:15], v[152:155], v[104:107], v[0:15]
    v_mfma_f32_32x32x16_bf16 v[16:31], v[152:155], v[108:111], v[16:31]
    s_waitcnt lgkmcnt(0)
    v_mfma_f32_32x32x16_bf16 v[32:47], v[156:159], v[104:107], v[32:47]
    v_mfma_f32_32x32x16_bf16 v[48:63], v[156:159], v[108:111], v[48:63]
    s_waitcnt vmcnt(8)
    ds_read_b64_tr_b16 v[128:129], v162 offset:0
    ds_read_b64_tr_b16 v[130:131], v162 offset:512
    ds_read_b64_tr_b16 v[132:133], v163 offset:0
    ds_read_b64_tr_b16 v[134:135], v163 offset:512
    ds_read_b64_tr_b16 v[136:137], v162 offset:2048
    ds_read_b64_tr_b16 v[138:139], v162 offset:2560
    ds_read_b64_tr_b16 v[140:141], v163 offset:2048
    ds_read_b64_tr_b16 v[142:143], v163 offset:2560
    s_add_u32 s41, s40, 8
    s_and_b32 s41, s41, 7
    s_add_u32 s42, s46, 8
    s_and_b32 s42, s42, 8
    s_or_b32 s41, s41, s42
    s_mul_i32 s42, s41, 36864
    s_lshl_b32 s41, s41, 11
    s_add_u32 s37, s41, 0
    buffer_load_dwordx4 v[96:99], v160, s[4:7], s37 offen offset:0 sc1
    s_add_u32 s37, s41, 262144
    buffer_load_dwordx4 v[100:103], v160, s[4:7], s37 offen offset:0 sc1
    s_add_u32 s37, s41, 0
    buffer_load_dwordx4 v[104:107], v160, s[4:7], s37 offen offset:1024 sc1
    s_add_u32 s37, s41, 262144
    buffer_load_dwordx4 v[108:111], v160, s[4:7], s37 offen offset:1024 sc1
    s_add_u32 m0, s36, 8192
    s_add_u32 s37, s42, 0
    buffer_load_dwordx4 v161, s[8:11], s37 offen lds
    s_add_u32 m0, s36, 9216
    s_add_u32 s37, s42, 9216
    buffer_load_dwordx4 v161, s[8:11], s37 offen lds
    s_add_u32 m0, s36, 10240
    s_add_u32 s37, s42, 18432
    buffer_load_dwordx4 v161, s[8:11], s37 offen lds
    s_add_u32 m0, s36, 11264
    s_add_u32 s37, s42, 27648
    buffer_load_dwordx4 v161, s[8:11], s37 offen lds
    s_waitcnt lgkmcnt(6)
    v_mfma_f32_32x32x16_bf16 v[0:15], v[128:131], v[64:67], v[0:15]
    v_mfma_f32_32x32x16_bf16 v[16:31], v[128:131], v[68:71], v[16:31]
    s_waitcnt lgkmcnt(4)
    v_mfma_f32_32x32x16_bf16 v[32:47], v[132:135], v[64:67], v[32:47]
    v_mfma_f32_32x32x16_bf16 v[48:63], v[132:135], v[68:71], v[48:63]
    s_waitcnt lgkmcnt(2)
    v_mfma_f32_32x32x16_bf16 v[0:15], v[136:139], v[72:75], v[0:15]
    v_mfma_f32_32x32x16_bf16 v[16:31], v[136:139], v[76:79], v[16:31]
    s_waitcnt lgkmcnt(0)
    v_mfma_f32_32x32x16_bf16 v[32:47], v[140:143], v[72:75], v[32:47]
    v_mfma_f32_32x32x16_bf16 v[48:63], v[140:143], v[76:79], v[48:63]
    s_waitcnt vmcnt(8)
    ds_read_b64_tr_b16 v[144:145], v162 offset:4096
    ds_read_b64_tr_b16 v[146:147], v162 offset:4608
    ds_read_b64_tr_b16 v[148:149], v163 offset:4096
    ds_read_b64_tr_b16 v[150:151], v163 offset:4608
    ds_read_b64_tr_b16 v[152:153], v162 offset:6144
    ds_read_b64_tr_b16 v[154:155], v162 offset:6656
    ds_read_b64_tr_b16 v[156:157], v163 offset:6144
    ds_read_b64_tr_b16 v[158:159], v163 offset:6656
    s_add_u32 s41, s40, 9
    s_and_b32 s41, s41, 7
    s_add_u32 s42, s46, 9
    s_and_b32 s42, s42, 8
    s_or_b32 s41, s41, s42
    s_mul_i32 s42, s41, 36864
    s_lshl_b32 s41, s41, 11
    s_add_u32 s37, s41, 0
    buffer_load_dwordx4 v[64:67], v160, s[4:7], s37 offen offset:0 sc1
    s_add_u32 s37, s41, 262144
    buffer_load_dwordx4 v[68:71], v160, s[4:7], s37 offen offset:0 sc1
    s_add_u32 s37, s41, 0
    buffer_load_dwordx4 v[72:75], v160, s[4:7], s37 offen offset:1024 sc1
    s_add_u32 s37, s41, 262144
    buffer_load_dwordx4 v[76:79], v160, s[4:7], s37 offen offset:1024 sc1
    s_add_u32 m0, s36, 0
    s_add_u32 s37, s42, 0
    buffer_load_dwordx4 v161, s[8:11], s37 offen lds
    s_add_u32 m0, s36, 1024
    s_add_u32 s37, s42, 9216
    buffer_load_dwordx4 v161, s[8:11], s37 offen lds
    s_add_u32 m0, s36, 2048
    s_add_u32 s37, s42, 18432
    buffer_load_dwordx4 v161, s[8:11], s37 offen lds
    s_add_u32 m0, s36, 3072
    s_add_u32 s37, s42, 27648
    buffer_load_dwordx4 v161, s[8:11], s37 offen lds
    s_waitcnt lgkmcnt(6)
    v_mfma_f32_32x32x16_bf16 v[0:15], v[144:147], v[80:83], v[0:15]
    v_mfma_f32_32x32x16_bf16 v[16:31], v[144:147], v[84:87], v[16:31]
    s_waitcnt lgkmcnt(4)
    v_mfma_f32_32x32x16_bf16 v[32:47], v[148:151], v[80:83], v[32:47]
    v_mfma_f32_32x32x16_bf16 v[48:63], v[148:151], v[84:87], v[48:63]
    s_waitcnt lgkmcnt(2)
    v_mfma_f32_32x32x16_bf16 v[0:15], v[152:155], v[88:91], v[0:15]
    v_mfma_f32_32x32x16_bf16 v[16:31], v[152:155], v[92:95], v[16:31]
    s_waitcnt lgkmcnt(0)
    v_mfma_f32_32x32x16_bf16 v[32:47], v[156:159], v[88:91], v[32:47]
    v_mfma_f32_32x32x16_bf16 v[48:63], v[156:159], v[92:95], v[48:63]
    s_waitcnt vmcnt(8)
    ds_read_b64_tr_b16 v[128:129], v162 offset:8192
    ds_read_b64_tr_b16 v[130:131], v162 offset:8704
    ds_read_b64_tr_b16 v[132:133], v163 offset:8192
    ds_read_b64_tr_b16 v[134:135], v163 offset:8704
    ds_read_b64_tr_b16 v[136:137], v162 offset:10240
    ds_read_b64_tr_b16 v[138:139], v162 offset:10752
    ds_read_b64_tr_b16 v[140:141], v163 offset:10240
    ds_read_b64_tr_b16 v[142:143], v163 offset:10752
    s_add_u32 s41, s40, 10
    s_and_b32 s41, s41, 7
    s_add_u32 s42, s46, 10
    s_and_b32 s42, s42, 8
    s_or_b32 s41, s41, s42
    s_mul_i32 s42, s41, 36864
    s_lshl_b32 s41, s41, 11
    s_add_u32 s37, s41, 0
    buffer_load_dwordx4 v[80:83], v160, s[4:7], s37 offen offset:0 sc1
    s_add_u32 s37, s41, 262144
    buffer_load_dwordx4 v[84:87], v160, s[4:7], s37 offen offset:0 sc1
    s_add_u32 s37, s41, 0
    buffer_load_dwordx4 v[88:91], v160, s[4:7], s37 offen offset:1024 sc1
    s_add_u32 s37, s41, 262144
    buffer_load_dwordx4 v[92:95], v160, s[4:7], s37 offen offset:1024 sc1
    s_add_u32 m0, s36, 4096
    s_add_u32 s37, s42, 0
    buffer_load_dwordx4 v161, s[8:11], s37 offen lds
    s_add_u32 m0, s36, 5120
    s_add_u32 s37, s42, 9216
    buffer_load_dwordx4 v161, s[8:11], s37 offen lds
    s_add_u32 m0, s36, 6144
    s_add_u32 s37, s42, 18432
    buffer_load_dwordx4 v161, s[8:11], s37 offen lds
    s_add_u32 m0, s36, 7168
    s_add_u32 s37, s42, 27648
    buffer_load_dwordx4 v161, s[8:11], s37 offen lds
    s_waitcnt lgkmcnt(6)
    v_mfma_f32_32x32x16_bf16 v[0:15], v[128:131], v[96:99], v[0:15]
    v_mfma_f32_32x32x16_bf16 v[16:31], v[128:131], v[100:103], v[16:31]
    s_waitcnt lgkmcnt(4)
    v_mfma_f32_32x32x16_bf16 v[32:47], v[132:135], v[96:99], v[32:47]
    v_mfma_f32_32x32x16_bf16 v[48:63], v[132:135], v[100:103], v[48:63]
    s_waitcnt lgkmcnt(2)
    v_mfma_f32_32x32x16_bf16 v[0:15], v[136:139], v[104:107], v[0:15]
    v_mfma_f32_32x32x16_bf16 v[16:31], v[136:139], v[108:111], v[16:31]
    s_waitcnt lgkmcnt(0)
    v_mfma_f32_32x32x16_bf16 v[32:47], v[140:143], v[104:107], v[32:47]
    v_mfma_f32_32x32x16_bf16 v[48:63], v[140:143], v[108:111], v[48:63]
    s_waitcnt vmcnt(8)
    ds_read_b64_tr_b16 v[144:145], v162 offset:0
    ds_read_b64_tr_b16 v[146:147], v162 offset:512
    ds_read_b64_tr_b16 v[148:149], v163 offset:0
    ds_read_b64_tr_b16 v[150:151], v163 offset:512
    ds_read_b64_tr_b16 v[152:153], v162 offset:2048
    ds_read_b64_tr_b16 v[154:155], v162 offset:2560
    ds_read_b64_tr_b16 v[156:157], v163 offset:2048
    ds_read_b64_tr_b16 v[158:159], v163 offset:2560
    s_add_u32 s41, s40, 11
    s_and_b32 s41, s41, 7
    s_add_u32 s42, s46, 11
    s_and_b32 s42, s42, 8
    s_or_b32 s41, s41, s42
    s_mul_i32 s42, s41, 36864
    s_lshl_b32 s41, s41, 11
    s_add_u32 s37, s41, 0
    buffer_load_dwordx4 v[96:99], v160, s[4:7], s37 offen offset:0 sc1
    s_add_u32 s37, s41, 262144
    buffer_load_dwordx4 v[100:103], v160, s[4:7], s37 offen offset:0 sc1
    s_add_u32 s37, s41, 0
    buffer_load_dwordx4 v[104:107], v160, s[4:7], s37 offen offset:1024 sc1
    s_add_u32 s37, s41, 262144
    buffer_load_dwordx4 v[108:111], v160, s[4:7], s37 offen offset:1024 sc1
    s_add_u32 m0, s36, 8192
    s_add_u32 s37, s42, 0
    buffer_load_dwordx4 v161, s[8:11], s37 offen lds
    s_add_u32 m0, s36, 9216
    s_add_u32 s37, s42, 9216
    buffer_load_dwordx4 v161, s[8:11], s37 offen lds
    s_add_u32 m0, s36, 10240
    s_add_u32 s37, s42, 18432
    buffer_load_dwordx4 v161, s[8:11], s37 offen lds
    s_add_u32 m0, s36, 11264
    s_add_u32 s37, s42, 27648
    buffer_load_dwordx4 v161, s[8:11], s37 offen lds
    s_waitcnt lgkmcnt(6)
    v_mfma_f32_32x32x16_bf16 v[0:15], v[144:147], v[64:67], v[0:15]
    v_mfma_f32_32x32x16_bf16 v[16:31], v[144:147], v[68:71], v[16:31]
    s_waitcnt lgkmcnt(4)
    v_mfma_f32_32x32x16_bf16 v[32:47], v[148:151], v[64:67], v[32:47]
    v_mfma_f32_32x32x16_bf16 v[48:63], v[148:151], v[68:71], v[48:63]
    s_waitcnt lgkmcnt(2)
    v_mfma_f32_32x32x16_bf16 v[0:15], v[152:155], v[72:75], v[0:15]
    v_mfma_f32_32x32x16_bf16 v[16:31], v[152:155], v[76:79], v[16:31]
    s_waitcnt lgkmcnt(0)
    v_mfma_f32_32x32x16_bf16 v[32:47], v[156:159], v[72:75], v[32:47]
    v_mfma_f32_32x32x16_bf16 v[48:63], v[156:159], v[76:79], v[48:63]
    s_waitcnt vmcnt(8)
    ds_read_b64_tr_b16 v[128:129], v162 offset:4096
    ds_read_b64_tr_b16 v[130:131], v162 offset:4608
    ds_read_b64_tr_b16 v[132:133], v163 offset:4096
    ds_read_b64_tr_b16 v[134:135], v163 offset:4608
    ds_read_b64_tr_b16 v[136:137], v162 offset:6144
    ds_read_b64_tr_b16 v[138:139], v162 offset:6656
    ds_read_b64_tr_b16 v[140:141], v163 offset:6144
    ds_read_b64_tr_b16 v[142:143], v163 offset:6656
    s_add_u32 s41, s40, 12
    s_and_b32 s41, s41, 7
    s_add_u32 s42, s46, 12
    s_and_b32 s42, s42, 8
    s_or_b32 s41, s41, s42
    s_mul_i32 s42, s41, 36864
    s_lshl_b32 s41, s41, 11
    s_add_u32 s37, s41, 0
    buffer_load_dwordx4 v[64:67], v160, s[4:7], s37 offen offset:0 sc1
    s_add_u32 s37, s41, 262144
    buffer_load_dwordx4 v[68:71], v160, s[4:7], s37 offen offset:0 sc1
    s_add_u32 s37, s41, 0
    buffer_load_dwordx4 v[72:75], v160, s[4:7], s37 offen offset:1024 sc1
    s_add_u32 s37, s41, 262144
    buffer_load_dwordx4 v[76:79], v160, s[4:7], s37 offen offset:1024 sc1
    s_waitcnt lgkmcnt(6)
    v_mfma_f32_32x32x16_bf16 v[0:15], v[128:131], v[80:83], v[0:15]
    v_mfma_f32_32x32x16_bf16 v[16:31], v[128:131], v[84:87], v[16:31]
    s_waitcnt lgkmcnt(4)
    v_mfma_f32_32x32x16_bf16 v[32:47], v[132:135], v[80:83], v[32:47]
    v_mfma_f32_32x32x16_bf16 v[48:63], v[132:135], v[84:87], v[48:63]
    s_waitcnt lgkmcnt(2)
    v_mfma_f32_32x32x16_bf16 v[0:15], v[136:139], v[88:91], v[0:15]
    v_mfma_f32_32x32x16_bf16 v[16:31], v[136:139], v[92:95], v[16:31]
    s_waitcnt lgkmcnt(0)
    v_mfma_f32_32x32x16_bf16 v[32:47], v[140:143], v[88:91], v[32:47]
    v_mfma_f32_32x32x16_bf16 v[48:63], v[140:143], v[92:95], v[48:63]
    s_waitcnt vmcnt(4)
    ds_read_b64_tr_b16 v[144:145], v162 offset:8192
    ds_read_b64_tr_b16 v[146:147], v162 offset:8704
    ds_read_b64_tr_b16 v[148:149], v163 offset:8192
    ds_read_b64_tr_b16 v[150:151], v163 offset:8704
    ds_read_b64_tr_b16 v[152:153], v162 offset:10240
    ds_read_b64_tr_b16 v[154:155], v162 offset:10752
    ds_read_b64_tr_b16 v[156:157], v163 offset:10240
    ds_read_b64_tr_b16 v[158:159], v163 offset:10752
    s_add_u32 s41, s40, 13
    s_and_b32 s41, s41, 7
    s_add_u32 s42, s46, 13
    s_and_b32 s42, s42, 8
    s_or_b32 s41, s41, s42
    s_mul_i32 s42, s41, 36864
    s_lshl_b32 s41, s41, 11
    s_add_u32 s37, s41, 0
    buffer_load_dwordx4 v[80:83], v160, s[4:7], s37 offen offset:0 sc1
    s_add_u32 s37, s41, 262144
    buffer_load_dwordx4 v[84:87], v160, s[4:7], s37 offen offset:0 sc1
    s_add_u32 s37, s41, 0
    buffer_load_dwordx4 v[88:91], v160, s[4:7], s37 offen offset:1024 sc1
    s_add_u32 s37, s41, 262144
    buffer_load_dwordx4 v[92:95], v160, s[4:7], s37 offen offset:1024 sc1
    s_waitcnt lgkmcnt(6)
    v_mfma_f32_32x32x16_bf16 v[0:15], v[144:147], v[96:99], v[0:15]
    v_mfma_f32_32x32x16_bf16 v[16:31], v[144:147], v[100:103], v[16:31]
    s_waitcnt lgkmcnt(4)
    v_mfma_f32_32x32x16_bf16 v[32:47], v[148:151], v[96:99], v[32:47]
    v_mfma_f32_32x32x16_bf16 v[48:63], v[148:151], v[100:103], v[48:63]
    s_waitcnt lgkmcnt(2)
    v_mfma_f32_32x32x16_bf16 v[0:15], v[152:155], v[104:107], v[0:15]
    v_mfma_f32_32x32x16_bf16 v[16:31], v[152:155], v[108:111], v[16:31]
    s_waitcnt lgkmcnt(0)
    v_mfma_f32_32x32x16_bf16 v[32:47], v[156:159], v[104:107], v[32:47]
    v_mfma_f32_32x32x16_bf16 v[48:63], v[156:159], v[108:111], v[48:63]
    s_waitcnt vmcnt(4)
    s_add_u32 s41, s40, 14
    s_and_b32 s41, s41, 7
    s_add_u32 s42, s46, 14
    s_and_b32 s42, s42, 8
    s_or_b32 s41, s41, s42
    s_mul_i32 s42, s41, 36864
    s_lshl_b32 s41, s41, 11
    s_add_u32 s37, s41, 0
    buffer_load_dwordx4 v[96:99], v160, s[4:7], s37 offen offset:0 sc1
    s_add_u32 s37, s41, 262144
    buffer_load_dwordx4 v[100:103], v160, s[4:7], s37 offen offset:0 sc1
    s_add_u32 s37, s41, 0
    buffer_load_dwordx4 v[104:107], v160, s[4:7], s37 offen offset:1024 sc1
    s_add_u32 s37, s41, 262144
    buffer_load_dwordx4 v[108:111], v160, s[4:7], s37 offen offset:1024 sc1
    s_waitcnt lgkmcnt(6)
    v_mfma_f32_32x32x16_bf16 v[0:15], v[168:171], v[64:67], v[0:15]
    v_mfma_f32_32x32x16_bf16 v[16:31], v[168:171], v[68:71], v[16:31]
    s_waitcnt lgkmcnt(4)
    v_mfma_f32_32x32x16_bf16 v[32:47], v[172:175], v[64:67], v[32:47]
    v_mfma_f32_32x32x16_bf16 v[48:63], v[172:175], v[68:71], v[48:63]
    s_waitcnt lgkmcnt(2)
    v_mfma_f32_32x32x16_bf16 v[0:15], v[176:179], v[72:75], v[0:15]
    v_mfma_f32_32x32x16_bf16 v[16:31], v[176:179], v[76:79], v[16:31]
    s_waitcnt lgkmcnt(0)
    v_mfma_f32_32x32x16_bf16 v[32:47], v[180:183], v[72:75], v[32:47]
    v_mfma_f32_32x32x16_bf16 v[48:63], v[180:183], v[76:79], v[48:63]
    s_waitcnt vmcnt(4)
    s_add_u32 s41, s40, 15
    s_and_b32 s41, s41, 7
    s_add_u32 s42, s46, 15
    s_and_b32 s42, s42, 8
    s_or_b32 s41, s41, s42
    s_mul_i32 s42, s41, 36864
    s_lshl_b32 s41, s41, 11
    s_add_u32 s37, s41, 0
    buffer_load_dwordx4 v[64:67], v160, s[4:7], s37 offen offset:0 sc1
    s_add_u32 s37, s41, 262144
    buffer_load_dwordx4 v[68:71], v160, s[4:7], s37 offen offset:0 sc1
    s_add_u32 s37, s41, 0
    buffer_load_dwordx4 v[72:75], v160, s[4:7], s37 offen offset:1024 sc1
    s_add_u32 s37, s41, 262144
    buffer_load_dwordx4 v[76:79], v160, s[4:7], s37 offen offset:1024 sc1
    s_waitcnt lgkmcnt(6)
    v_mfma_f32_32x32x16_bf16 v[0:15], v[184:187], v[80:83], v[0:15]
    v_mfma_f32_32x32x16_bf16 v[16:31], v[184:187], v[84:87], v[16:31]
    s_waitcnt lgkmcnt(4)
    v_mfma_f32_32x32x16_bf16 v[32:47], v[188:191], v[80:83], v[32:47]
    v_mfma_f32_32x32x16_bf16 v[48:63], v[188:191], v[84:87], v[48:63]
    s_waitcnt lgkmcnt(2)
    v_mfma_f32_32x32x16_bf16 v[0:15], v[192:195], v[88:91], v[0:15]
    v_mfma_f32_32x32x16_bf16 v[16:31], v[192:195], v[92:95], v[16:31]
    s_waitcnt lgkmcnt(0)
    v_mfma_f32_32x32x16_bf16 v[32:47], v[196:199], v[88:91], v[32:47]
    v_mfma_f32_32x32x16_bf16 v[48:63], v[196:199], v[92:95], v[48:63]
    s_waitcnt vmcnt(4)
    s_waitcnt lgkmcnt(6)
    v_mfma_f32_32x32x16_bf16 v[0:15], v[200:203], v[96:99], v[0:15]
    v_mfma_f32_32x32x16_bf16 v[16:31], v[200:203], v[100:103], v[16:31]
    s_waitcnt lgkmcnt(4)
    v_mfma_f32_32x32x16_bf16 v[32:47], v[204:207], v[96:99], v[32:47]
    v_mfma_f32_32x32x16_bf16 v[48:63], v[204:207], v[100:103], v[48:63]
    s_waitcnt lgkmcnt(2)
    v_mfma_f32_32x32x16_bf16 v[0:15], v[208:211], v[104:107], v[0:15]
    v_mfma_f32_32x32x16_bf16 v[16:31], v[208:211], v[108:111], v[16:31]
    s_waitcnt lgkmcnt(0)
    v_mfma_f32_32x32x16_bf16 v[32:47], v[212:215], v[104:107], v[32:47]
    v_mfma_f32_32x32x16_bf16 v[48:63], v[212:215], v[108:111], v[48:63]
    s_waitcnt vmcnt(0)
    s_waitcnt lgkmcnt(6)
    v_mfma_f32_32x32x16_bf16 v[0:15], v[216:219], v[64:67], v[0:15]
    v_mfma_f32_32x32x16_bf16 v[16:31], v[216:219], v[68:71], v[16:31]
    s_waitcnt lgkmcnt(4)
    v_mfma_f32_32x32x16_bf16 v[32:47], v[220:223], v[64:67], v[32:47]
    v_mfma_f32_32x32x16_bf16 v[48:63], v[220:223], v[68:71], v[48:63]
    s_waitcnt lgkmcnt(2)
    v_mfma_f32_32x32x16_bf16 v[0:15], v[224:227], v[72:75], v[0:15]
    v_mfma_f32_32x32x16_bf16 v[16:31], v[224:227], v[76:79], v[16:31]
    s_waitcnt lgkmcnt(0)
    v_mfma_f32_32x32x16_bf16 v[32:47], v[228:231], v[72:75], v[32:47]
    v_mfma_f32_32x32x16_bf16 v[48:63], v[228:231], v[76:79], v[48:63]
    v_add_u32 v164, s36, v160
    s_lshl_b32 s37, s32, 12
    v_add_u32 v165, s37, v160
    s_nop 7
    s_nop 3
    ds_write_b128 v164, v[0:3] offset:0
    ds_write_b128 v164, v[4:7] offset:1024
    ds_write_b128 v164, v[8:11] offset:2048
    ds_write_b128 v164, v[12:15] offset:3072
    ds_write_b128 v164, v[16:19] offset:4096
    ds_write_b128 v164, v[20:23] offset:5120
    ds_write_b128 v164, v[24:27] offset:6144
    ds_write_b128 v164, v[28:31] offset:7168
    ds_write_b128 v164, v[32:35] offset:8192
    ds_write_b128 v164, v[36:39] offset:9216
    ds_write_b128 v164, v[40:43] offset:10240
    ds_write_b128 v164, v[44:47] offset:11264
    ds_write_b128 v164, v[48:51] offset:12288
    ds_write_b128 v164, v[52:55] offset:13312
    ds_write_b128 v164, v[56:59] offset:14336
    ds_write_b128 v164, v[60:63] offset:15360
    s_waitcnt lgkmcnt(0)
    s_barrier
    ds_read_b128 v[0:3], v165 offset:0
    ds_read_b128 v[4:7], v165 offset:1024
    ds_read_b128 v[8:11], v165 offset:2048
    ds_read_b128 v[12:15], v165 offset:3072
    ds_read_b128 v[16:19], v165 offset:16384
    ds_read_b128 v[20:23], v165 offset:17408
    ds_read_b128 v[24:27], v165 offset:18432
    ds_read_b128 v[28:31], v165 offset:19456
    ds_read_b128 v[32:35], v165 offset:32768
    ds_read_b128 v[36:39], v165 offset:33792
    ds_read_b128 v[40:43], v165 offset:34816
    ds_read_b128 v[44:47], v165 offset:35840
    s_waitcnt lgkmcnt(8)
    ds_read_b128 v[48:51], v165 offset:49152
    ds_read_b128 v[52:55], v165 offset:50176
    ds_read_b128 v[56:59], v165 offset:51200
    ds_read_b128 v[60:63], v165 offset:52224
    s_lshl_b32 s37, s30, 6
    s_and_b32 s38, s32, 1
    s_lshl_b32 s38, s38, 5
    s_add_u32 s37, s37, s38
    v_and_b32 v164, 31, v244
    v_add_u32 v164, s37, v164
    v_mul_u32_u24 v164, 1152, v164
    s_lshr_b32 s38, s32, 1
    s_lshl_b32 s38, s38, 6
    s_add_u32 s38, s38, s35
    v_lshrrev_b32 v163, 5, v244
    v_lshl_add_u32 v164, v163, 4, v164
    v_add_u32 v164, s38, v164
    s_waitcnt lgkmcnt(0)
    v_pk_add_f32 v[0:1], v[0:1], v[32:33]
    v_pk_add_f32 v[2:3], v[2:3], v[34:35]
    v_pk_add_f32 v[4:5], v[4:5], v[36:37]
    v_pk_add_f32 v[6:7], v[6:7], v[38:39]
    v_pk_add_f32 v[8:9], v[8:9], v[40:41]
    v_pk_add_f32 v[10:11], v[10:11], v[42:43]
    v_pk_add_f32 v[12:13], v[12:13], v[44:45]
    v_pk_add_f32 v[14:15], v[14:15], v[46:47]
    v_pk_add_f32 v[16:17], v[16:17], v[48:49]
    v_pk_add_f32 v[18:19], v[18:19], v[50:51]
    v_pk_add_f32 v[20:21], v[20:21], v[52:53]
    v_pk_add_f32 v[22:23], v[22:23], v[54:55]
    v_pk_add_f32 v[24:25], v[24:25], v[56:57]
    v_pk_add_f32 v[26:27], v[26:27], v[58:59]
    v_pk_add_f32 v[28:29], v[28:29], v[60:61]
    v_pk_add_f32 v[30:31], v[30:31], v[62:63]
    v_pk_add_f32 v[0:1], v[0:1], v[16:17]
    v_pk_add_f32 v[2:3], v[2:3], v[18:19]
    v_pk_add_f32 v[4:5], v[4:5], v[20:21]
    v_pk_add_f32 v[6:7], v[6:7], v[22:23]
    v_pk_add_f32 v[8:9], v[8:9], v[24:25]
    v_pk_add_f32 v[10:11], v[10:11], v[26:27]
    v_pk_add_f32 v[12:13], v[12:13], v[28:29]
    v_pk_add_f32 v[14:15], v[14:15], v[30:31]
    v_cvt_pk_bf16_f32 v16, v0, v1
    v_cvt_pk_bf16_f32 v17, v2, v3
    v_cvt_pk_bf16_f32 v18, v4, v5
    v_cvt_pk_bf16_f32 v19, v6, v7
    v_cvt_pk_bf16_f32 v20, v8, v9
    v_cvt_pk_bf16_f32 v21, v10, v11
    v_cvt_pk_bf16_f32 v22, v12, v13
    v_cvt_pk_bf16_f32 v23, v14, v15
    buffer_store_dwordx4 v[16:19], v164, s[12:15], 0 offen
    buffer_store_dwordx4 v[20:23], v164, s[12:15], 0 offen offset:32
K1_FLUSH:
K1_END:
    s_endpgm
K1_RS0:
    v_mov_b32 v241, v240
    s_nop 1
    v_permlane32_swap_b32 v241, v240
    s_nop 1
    v_max_f32 v240, v240, v241
    v_mul_f32 v234, v242, v240
    v_fma_f32 v236, v232, v242, -v234
    v_mov_b32 v232, v240
    v_exp_f32 v236, v236
    v_add_f32 v233, 0x427af233, v240
    s_nop 7
    s_branch K1_RB0
K1_RS1:
    v_mov_b32 v241, v240
    s_nop 1
    v_permlane32_swap_b32 v241, v240
    s_nop 1
    v_max_f32 v240, v240, v241
    v_mul_f32 v234, v242, v240
    v_fma_f32 v236, v232, v242, -v234
    v_mov_b32 v232, v240
    v_exp_f32 v236, v236
    v_add_f32 v233, 0x427af233, v240
    s_nop 7
    v_pk_mul_f32 v[238:239], v[238:239], v[236:237] op_sel_hi:[1,0]
    v_pk_mul_f32 v[0:1], v[0:1], v[236:237] op_sel_hi:[1,0]
    v_pk_mul_f32 v[2:3], v[2:3], v[236:237] op_sel_hi:[1,0]
    v_pk_mul_f32 v[4:5], v[4:5], v[236:237] op_sel_hi:[1,0]
    v_pk_mul_f32 v[6:7], v[6:7], v[236:237] op_sel_hi:[1,0]
    v_pk_mul_f32 v[8:9], v[8:9], v[236:237] op_sel_hi:[1,0]
    v_pk_mul_f32 v[10:11], v[10:11], v[236:237] op_sel_hi:[1,0]
    v_pk_mul_f32 v[12:13], v[12:13], v[236:237] op_sel_hi:[1,0]
    v_pk_mul_f32 v[14:15], v[14:15], v[236:237] op_sel_hi:[1,0]
    v_pk_mul_f32 v[16:17], v[16:17], v[236:237] op_sel_hi:[1,0]
    v_pk_mul_f32 v[18:19], v[18:19], v[236:237] op_sel_hi:[1,0]
    v_pk_mul_f32 v[20:21], v[20:21], v[236:237] op_sel_hi:[1,0]
    v_pk_mul_f32 v[22:23], v[22:23], v[236:237] op_sel_hi:[1,0]
    v_pk_mul_f32 v[24:25], v[24:25], v[236:237] op_sel_hi:[1,0]
    v_pk_mul_f32 v[26:27], v[26:27], v[236:237] op_sel_hi:[1,0]
    v_pk_mul_f32 v[28:29], v[28:29], v[236:237] op_sel_hi:[1,0]
    v_pk_mul_f32 v[30:31], v[30:31], v[236:237] op_sel_hi:[1,0]
    v_pk_mul_f32 v[32:33], v[32:33], v[236:237] op_sel_hi:[1,0]
    v_pk_mul_f32 v[34:35], v[34:35], v[236:237] op_sel_hi:[1,0]
    v_pk_mul_f32 v[36:37], v[36:37], v[236:237] op_sel_hi:[1,0]
    v_pk_mul_f32 v[38:39], v[38:39], v[236:237] op_sel_hi:[1,0]
    v_pk_mul_f32 v[40:41], v[40:41], v[236:237] op_sel_hi:[1,0]
    v_pk_mul_f32 v[42:43], v[42:43], v[236:237] op_sel_hi:[1,0]
    v_pk_mul_f32 v[44:45], v[44:45], v[236:237] op_sel_hi:[1,0]
    v_pk_mul_f32 v[46:47], v[46:47], v[236:237] op_sel_hi:[1,0]
    v_pk_mul_f32 v[48:49], v[48:49], v[236:237] op_sel_hi:[1,0]
    v_pk_mul_f32 v[50:51], v[50:51], v[236:237] op_sel_hi:[1,0]
    v_pk_mul_f32 v[52:53], v[52:53], v[236:237] op_sel_hi:[1,0]
    v_pk_mul_f32 v[54:55], v[54:55], v[236:237] op_sel_hi:[1,0]
    v_pk_mul_f32 v[56:57], v[56:57], v[236:237] op_sel_hi:[1,0]
    v_pk_mul_f32 v[58:59], v[58:59], v[236:237] op_sel_hi:[1,0]
    v_pk_mul_f32 v[60:61], v[60:61], v[236:237] op_sel_hi:[1,0]
    v_pk_mul_f32 v[62:63], v[62:63], v[236:237] op_sel_hi:[1,0]
    s_branch K1_RB1
K1_RS2:
    v_mov_b32 v241, v240
    s_nop 1
    v_permlane32_swap_b32 v241, v240
    s_nop 1
    v_max_f32 v240, v240, v241
    v_mul_f32 v234, v242, v240
    v_fma_f32 v236, v232, v242, -v234
    v_mov_b32 v232, v240
    v_exp_f32 v236, v236
    v_add_f32 v233, 0x427af233, v240
    s_nop 7
    v_pk_mul_f32 v[238:239], v[238:239], v[236:237] op_sel_hi:[1,0]
    v_pk_mul_f32 v[0:1], v[0:1], v[236:237] op_sel_hi:[1,0]
    v_pk_mul_f32 v[2:3], v[2:3], v[236:237] op_sel_hi:[1,0]
    v_pk_mul_f32 v[4:5], v[4:5], v[236:237] op_sel_hi:[1,0]
    v_pk_mul_f32 v[6:7], v[6:7], v[236:237] op_sel_hi:[1,0]
    v_pk_mul_f32 v[8:9], v[8:9], v[236:237] op_sel_hi:[1,0]
    v_pk_mul_f32 v[10:11], v[10:11], v[236:237] op_sel_hi:[1,0]
    v_pk_mul_f32 v[12:13], v[12:13], v[236:237] op_sel_hi:[1,0]
    v_pk_mul_f32 v[14:15], v[14:15], v[236:237] op_sel_hi:[1,0]
    v_pk_mul_f32 v[16:17], v[16:17], v[236:237] op_sel_hi:[1,0]
    v_pk_mul_f32 v[18:19], v[18:19], v[236:237] op_sel_hi:[1,0]
    v_pk_mul_f32 v[20:21], v[20:21], v[236:237] op_sel_hi:[1,0]
    v_pk_mul_f32 v[22:23], v[22:23], v[236:237] op_sel_hi:[1,0]
    v_pk_mul_f32 v[24:25], v[24:25], v[236:237] op_sel_hi:[1,0]
    v_pk_mul_f32 v[26:27], v[26:27], v[236:237] op_sel_hi:[1,0]
    v_pk_mul_f32 v[28:29], v[28:29], v[236:237] op_sel_hi:[1,0]
    v_pk_mul_f32 v[30:31], v[30:31], v[236:237] op_sel_hi:[1,0]
    v_pk_mul_f32 v[32:33], v[32:33], v[236:237] op_sel_hi:[1,0]
    v_pk_mul_f32 v[34:35], v[34:35], v[236:237] op_sel_hi:[1,0]
    v_pk_mul_f32 v[36:37], v[36:37], v[236:237] op_sel_hi:[1,0]
    v_pk_mul_f32 v[38:39], v[38:39], v[236:237] op_sel_hi:[1,0]
    v_pk_mul_f32 v[40:41], v[40:41], v[236:237] op_sel_hi:[1,0]
    v_pk_mul_f32 v[42:43], v[42:43], v[236:237] op_sel_hi:[1,0]
    v_pk_mul_f32 v[44:45], v[44:45], v[236:237] op_sel_hi:[1,0]
    v_pk_mul_f32 v[46:47], v[46:47], v[236:237] op_sel_hi:[1,0]
    v_pk_mul_f32 v[48:49], v[48:49], v[236:237] op_sel_hi:[1,0]
    v_pk_mul_f32 v[50:51], v[50:51], v[236:237] op_sel_hi:[1,0]
    v_pk_mul_f32 v[52:53], v[52:53], v[236:237] op_sel_hi:[1,0]
    v_pk_mul_f32 v[54:55], v[54:55], v[236:237] op_sel_hi:[1,0]
    v_pk_mul_f32 v[56:57], v[56:57], v[236:237] op_sel_hi:[1,0]
    v_pk_mul_f32 v[58:59], v[58:59], v[236:237] op_sel_hi:[1,0]
    v_pk_mul_f32 v[60:61], v[60:61], v[236:237] op_sel_hi:[1,0]
    v_pk_mul_f32 v[62:63], v[62:63], v[236:237] op_sel_hi:[1,0]
    s_branch K1_RB2
K1_RS3:
    v_mov_b32 v241, v240
    s_nop 1
    v_permlane32_swap_b32 v241, v240
    s_nop 1
    v_max_f32 v240, v240, v241
    v_mul_f32 v234, v242, v240
    v_fma_f32 v236, v232, v242, -v234
    v_mov_b32 v232, v240
    v_exp_f32 v236, v236
    v_add_f32 v233, 0x427af233, v240
    s_nop 7
    v_pk_mul_f32 v[238:239], v[238:239], v[236:237] op_sel_hi:[1,0]
    v_pk_mul_f32 v[0:1], v[0:1], v[236:237] op_sel_hi:[1,0]
    v_pk_mul_f32 v[2:3], v[2:3], v[236:237] op_sel_hi:[1,0]
    v_pk_mul_f32 v[4:5], v[4:5], v[236:237] op_sel_hi:[1,0]
    v_pk_mul_f32 v[6:7], v[6:7], v[236:237] op_sel_hi:[1,0]
    v_pk_mul_f32 v[8:9], v[8:9], v[236:237] op_sel_hi:[1,0]
    v_pk_mul_f32 v[10:11], v[10:11], v[236:237] op_sel_hi:[1,0]
    v_pk_mul_f32 v[12:13], v[12:13], v[236:237] op_sel_hi:[1,0]
    v_pk_mul_f32 v[14:15], v[14:15], v[236:237] op_sel_hi:[1,0]
    v_pk_mul_f32 v[16:17], v[16:17], v[236:237] op_sel_hi:[1,0]
    v_pk_mul_f32 v[18:19], v[18:19], v[236:237] op_sel_hi:[1,0]
    v_pk_mul_f32 v[20:21], v[20:21], v[236:237] op_sel_hi:[1,0]
    v_pk_mul_f32 v[22:23], v[22:23], v[236:237] op_sel_hi:[1,0]
    v_pk_mul_f32 v[24:25], v[24:25], v[236:237] op_sel_hi:[1,0]
    v_pk_mul_f32 v[26:27], v[26:27], v[236:237] op_sel_hi:[1,0]
    v_pk_mul_f32 v[28:29], v[28:29], v[236:237] op_sel_hi:[1,0]
    v_pk_mul_f32 v[30:31], v[30:31], v[236:237] op_sel_hi:[1,0]
    v_pk_mul_f32 v[32:33], v[32:33], v[236:237] op_sel_hi:[1,0]
    v_pk_mul_f32 v[34:35], v[34:35], v[236:237] op_sel_hi:[1,0]
    v_pk_mul_f32 v[36:37], v[36:37], v[236:237] op_sel_hi:[1,0]
    v_pk_mul_f32 v[38:39], v[38:39], v[236:237] op_sel_hi:[1,0]
    v_pk_mul_f32 v[40:41], v[40:41], v[236:237] op_sel_hi:[1,0]
    v_pk_mul_f32 v[42:43], v[42:43], v[236:237] op_sel_hi:[1,0]
    v_pk_mul_f32 v[44:45], v[44:45], v[236:237] op_sel_hi:[1,0]
    v_pk_mul_f32 v[46:47], v[46:47], v[236:237] op_sel_hi:[1,0]
    v_pk_mul_f32 v[48:49], v[48:49], v[236:237] op_sel_hi:[1,0]
    v_pk_mul_f32 v[50:51], v[50:51], v[236:237] op_sel_hi:[1,0]
    v_pk_mul_f32 v[52:53], v[52:53], v[236:237] op_sel_hi:[1,0]
    v_pk_mul_f32 v[54:55], v[54:55], v[236:237] op_sel_hi:[1,0]
    v_pk_mul_f32 v[56:57], v[56:57], v[236:237] op_sel_hi:[1,0]
    v_pk_mul_f32 v[58:59], v[58:59], v[236:237] op_sel_hi:[1,0]
    v_pk_mul_f32 v[60:61], v[60:61], v[236:237] op_sel_hi:[1,0]
    v_pk_mul_f32 v[62:63], v[62:63], v[236:237] op_sel_hi:[1,0]
    s_branch K1_RB3
K1_RS4:
    v_mov_b32 v241, v240
    s_nop 1
    v_permlane32_swap_b32 v241, v240
    s_nop 1
    v_max_f32 v240, v240, v241
    v_mul_f32 v234, v242, v240
    v_fma_f32 v236, v232, v242, -v234
    v_mov_b32 v232, v240
    v_exp_f32 v236, v236
    v_add_f32 v233, 0x427af233, v240
    s_nop 7
    v_pk_mul_f32 v[238:239], v[238:239], v[236:237] op_sel_hi:[1,0]
    v_pk_mul_f32 v[0:1], v[0:1], v[236:237] op_sel_hi:[1,0]
    v_pk_mul_f32 v[2:3], v[2:3], v[236:237] op_sel_hi:[1,0]
    v_pk_mul_f32 v[4:5], v[4:5], v[236:237] op_sel_hi:[1,0]
    v_pk_mul_f32 v[6:7], v[6:7], v[236:237] op_sel_hi:[1,0]
    v_pk_mul_f32 v[8:9], v[8:9], v[236:237] op_sel_hi:[1,0]
    v_pk_mul_f32 v[10:11], v[10:11], v[236:237] op_sel_hi:[1,0]
    v_pk_mul_f32 v[12:13], v[12:13], v[236:237] op_sel_hi:[1,0]
    v_pk_mul_f32 v[14:15], v[14:15], v[236:237] op_sel_hi:[1,0]
    v_pk_mul_f32 v[16:17], v[16:17], v[236:237] op_sel_hi:[1,0]
    v_pk_mul_f32 v[18:19], v[18:19], v[236:237] op_sel_hi:[1,0]
    v_pk_mul_f32 v[20:21], v[20:21], v[236:237] op_sel_hi:[1,0]
    v_pk_mul_f32 v[22:23], v[22:23], v[236:237] op_sel_hi:[1,0]
    v_pk_mul_f32 v[24:25], v[24:25], v[236:237] op_sel_hi:[1,0]
    v_pk_mul_f32 v[26:27], v[26:27], v[236:237] op_sel_hi:[1,0]
    v_pk_mul_f32 v[28:29], v[28:29], v[236:237] op_sel_hi:[1,0]
    v_pk_mul_f32 v[30:31], v[30:31], v[236:237] op_sel_hi:[1,0]
    v_pk_mul_f32 v[32:33], v[32:33], v[236:237] op_sel_hi:[1,0]
    v_pk_mul_f32 v[34:35], v[34:35], v[236:237] op_sel_hi:[1,0]
    v_pk_mul_f32 v[36:37], v[36:37], v[236:237] op_sel_hi:[1,0]
    v_pk_mul_f32 v[38:39], v[38:39], v[236:237] op_sel_hi:[1,0]
    v_pk_mul_f32 v[40:41], v[40:41], v[236:237] op_sel_hi:[1,0]
    v_pk_mul_f32 v[42:43], v[42:43], v[236:237] op_sel_hi:[1,0]
    v_pk_mul_f32 v[44:45], v[44:45], v[236:237] op_sel_hi:[1,0]
    v_pk_mul_f32 v[46:47], v[46:47], v[236:237] op_sel_hi:[1,0]
    v_pk_mul_f32 v[48:49], v[48:49], v[236:237] op_sel_hi:[1,0]
    v_pk_mul_f32 v[50:51], v[50:51], v[236:237] op_sel_hi:[1,0]
    v_pk_mul_f32 v[52:53], v[52:53], v[236:237] op_sel_hi:[1,0]
    v_pk_mul_f32 v[54:55], v[54:55], v[236:237] op_sel_hi:[1,0]
    v_pk_mul_f32 v[56:57], v[56:57], v[236:237] op_sel_hi:[1,0]
    v_pk_mul_f32 v[58:59], v[58:59], v[236:237] op_sel_hi:[1,0]
    v_pk_mul_f32 v[60:61], v[60:61], v[236:237] op_sel_hi:[1,0]
    v_pk_mul_f32 v[62:63], v[62:63], v[236:237] op_sel_hi:[1,0]
    s_branch K1_RB4
K1_RS5:
    v_mov_b32 v241, v240
    s_nop 1
    v_permlane32_swap_b32 v241, v240
    s_nop 1
    v_max_f32 v240, v240, v241
    v_mul_f32 v234, v242, v240
    v_fma_f32 v236, v232, v242, -v234
    v_mov_b32 v232, v240
    v_exp_f32 v236, v236
    v_add_f32 v233, 0x427af233, v240
    s_nop 7
    v_pk_mul_f32 v[238:239], v[238:239], v[236:237] op_sel_hi:[1,0]
    v_pk_mul_f32 v[0:1], v[0:1], v[236:237] op_sel_hi:[1,0]
    v_pk_mul_f32 v[2:3], v[2:3], v[236:237] op_sel_hi:[1,0]
    v_pk_mul_f32 v[4:5], v[4:5], v[236:237] op_sel_hi:[1,0]
    v_pk_mul_f32 v[6:7], v[6:7], v[236:237] op_sel_hi:[1,0]
    v_pk_mul_f32 v[8:9], v[8:9], v[236:237] op_sel_hi:[1,0]
    v_pk_mul_f32 v[10:11], v[10:11], v[236:237] op_sel_hi:[1,0]
    v_pk_mul_f32 v[12:13], v[12:13], v[236:237] op_sel_hi:[1,0]
    v_pk_mul_f32 v[14:15], v[14:15], v[236:237] op_sel_hi:[1,0]
    v_pk_mul_f32 v[16:17], v[16:17], v[236:237] op_sel_hi:[1,0]
    v_pk_mul_f32 v[18:19], v[18:19], v[236:237] op_sel_hi:[1,0]
    v_pk_mul_f32 v[20:21], v[20:21], v[236:237] op_sel_hi:[1,0]
    v_pk_mul_f32 v[22:23], v[22:23], v[236:237] op_sel_hi:[1,0]
    v_pk_mul_f32 v[24:25], v[24:25], v[236:237] op_sel_hi:[1,0]
    v_pk_mul_f32 v[26:27], v[26:27], v[236:237] op_sel_hi:[1,0]
    v_pk_mul_f32 v[28:29], v[28:29], v[236:237] op_sel_hi:[1,0]
    v_pk_mul_f32 v[30:31], v[30:31], v[236:237] op_sel_hi:[1,0]
    v_pk_mul_f32 v[32:33], v[32:33], v[236:237] op_sel_hi:[1,0]
    v_pk_mul_f32 v[34:35], v[34:35], v[236:237] op_sel_hi:[1,0]
    v_pk_mul_f32 v[36:37], v[36:37], v[236:237] op_sel_hi:[1,0]
    v_pk_mul_f32 v[38:39], v[38:39], v[236:237] op_sel_hi:[1,0]
    v_pk_mul_f32 v[40:41], v[40:41], v[236:237] op_sel_hi:[1,0]
    v_pk_mul_f32 v[42:43], v[42:43], v[236:237] op_sel_hi:[1,0]
    v_pk_mul_f32 v[44:45], v[44:45], v[236:237] op_sel_hi:[1,0]
    v_pk_mul_f32 v[46:47], v[46:47], v[236:237] op_sel_hi:[1,0]
    v_pk_mul_f32 v[48:49], v[48:49], v[236:237] op_sel_hi:[1,0]
    v_pk_mul_f32 v[50:51], v[50:51], v[236:237] op_sel_hi:[1,0]
    v_pk_mul_f32 v[52:53], v[52:53], v[236:237] op_sel_hi:[1,0]
    v_pk_mul_f32 v[54:55], v[54:55], v[236:237] op_sel_hi:[1,0]
    v_pk_mul_f32 v[56:57], v[56:57], v[236:237] op_sel_hi:[1,0]
    v_pk_mul_f32 v[58:59], v[58:59], v[236:237] op_sel_hi:[1,0]
    v_pk_mul_f32 v[60:61], v[60:61], v[236:237] op_sel_hi:[1,0]
    v_pk_mul_f32 v[62:63], v[62:63], v[236:237] op_sel_hi:[1,0]
    s_branch K1_RB5
.section .rodata,"a"
.p2align 6
.amdhsa_kernel standalone__mha_block_cached__near_ridge_kernel
  .amdhsa_next_free_vgpr 248
  .amdhsa_next_free_sgpr 96
  .amdhsa_accum_offset 248
  .amdhsa_group_segment_fixed_size 0
  .amdhsa_kernarg_size 64
  .amdhsa_user_sgpr_count 2
  .amdhsa_user_sgpr_kernarg_segment_ptr 1
  .amdhsa_system_sgpr_workgroup_id_x 1
.end_amdhsa_kernel
```
